```python
import torch

def _softmax(x, axis=-1):
    return torch.softmax(x, dim=axis)

def _gelu(x):
    return torch.nn.functional.gelu(x, approximate='tanh')

def _silu(x):
    return torch.nn.functional.silu(x)

def _sigmoid(x):
    return torch.sigmoid(x)

def _layernorm(x, axis=-1, eps=1e-05):
    m = x.mean(dim=axis, keepdim=True)
    v = x.var(dim=axis, keepdim=True, unbiased=False)
    return (x - m) / torch.sqrt(v + eps)

def _scatter_add(tgt, idx, src, axis=0):
    return tgt.clone().index_add_(axis, idx, src)

def _segment_sum(src, seg, n):
    out = torch.zeros((n,) + src.shape[1:], dtype=src.dtype)
    return out.index_add_(0, seg, src)

def _pad(x, pw):
    flat = tuple((v for pair in reversed(pw) for v in pair))
    return torch.nn.functional.pad(x, flat)
kernel_name = 'adaLN_cond__sliding_block_cached__glu_gated_swiglu__decode'

def setup_inputs():

    _w = lambda a: (lambda t: t.to(torch.bfloat16) if t.is_floating_point() else t)(torch.as_tensor(a))

    def _A_setup():
        B, Sq, D = (8, 1, 448)
        Hq, Hkv, Sk, Dh = (16, 8, 4096, 256)
        assert Hq % Hkv == 0, (Hq, Hkv)
        return {'x': _w((lambda *s: torch.randn(*s, dtype=torch.bfloat16) * 0.1)(B, Sq, D)), 'k_cache': _w((lambda *s: torch.randn(*s, dtype=torch.bfloat16) * 0.8)(B, Hkv, Sk, Dh)), 'v_cache': _w((lambda *s: torch.randn(*s, dtype=torch.bfloat16) * 3.2)(B, Hkv, Sk, Dh)), 'wq': _w((lambda *s: torch.randn(*s, dtype=torch.bfloat16) * 0.8)(D, Hq * Dh) * D ** (-0.5)), 'wo': _w((lambda *s: torch.randn(*s, dtype=torch.bfloat16) * 3.2)(Hq * Dh, D) * (Hq * Dh) ** (-0.5))}
    _A_in = _A_setup()

    def _B_setup():
        B, S, D, F = (8, 1, 448, 1792)
        return {'x': _w((lambda *s: torch.randn(*s, dtype=torch.bfloat16) * 0.1)(B, S, D)), 'w1': _w((lambda *s: torch.randn(*s, dtype=torch.bfloat16) * 3.2)(D, F) * (2.0 / D) ** 0.5), 'w3': _w((lambda *s: torch.randn(*s, dtype=torch.bfloat16) * 3.2)(D, F) * (2.0 / D) ** 0.5), 'w2': _w((lambda *s: torch.randn(*s, dtype=torch.bfloat16) * 3.2)(F, D) * (2.0 / F) ** 0.5)}
    _B_in = _B_setup()
    return {'A_x': _A_in['x'], 'A_k_cache': _A_in['k_cache'], 'A_v_cache': _A_in['v_cache'], 'A_wq': _A_in['wq'], 'A_wo': _A_in['wo'], 'B_x': _B_in['x'], 'B_w1': _B_in['w1'], 'B_w3': _B_in['w3'], 'B_w2': _B_in['w2'], 'c': _w((lambda *s: torch.randn(*s, dtype=torch.bfloat16) * 0.8)(8, 448) * 8.0), 'w_mod': _w((lambda *s: torch.randn(*s, dtype=torch.bfloat16) * 0.8)(448, 6 * 448) * 448 ** (-0.5) * 8.0)}

def reference(A_x, A_k_cache, A_v_cache, A_wq, A_wo, B_x, B_w1, B_w3, B_w2, c, w_mod):

    def _A_ref(x, k_cache, v_cache, wq, wo):
        B, Sq, D = x.shape
        Hq, Dh = (16, 256)
        Hkv, Sk = (k_cache.shape[1], k_cache.shape[2])
        W = min(4096, max(256, Sk // 4))
        rep = Hq // Hkv
        q = (lambda x, *d: x.permute(*d))((x @ wq).reshape(B, Sq, Hq, Dh), 0, 2, 1, 3)
        k = (lambda x, n, axis: torch.repeat_interleave(x, n, dim=axis))(k_cache[:, :, Sk - W:, :], rep, axis=1)
        v = (lambda x, n, axis: torch.repeat_interleave(x, n, dim=axis))(v_cache[:, :, Sk - W:, :], rep, axis=1)
        scores = torch.einsum('bhqd,bhkd->bhqk', q, k) * Dh ** (-0.5)
        p = _softmax(scores, axis=-1)
        o = torch.einsum('bhqk,bhkd->bhqd', p, v)
        return (lambda x, *d: x.permute(*d))(o, 0, 2, 1, 3).reshape(B, Sq, Hq * Dh) @ wo

    def _B_ref(x, w1, w3, w2):
        gate = torch.einsum('bsd,df->bsf', x, w1)
        up = torch.einsum('bsd,df->bsf', x, w3)
        h = _silu(gate) * up
        out = torch.einsum('bsf,fd->bsd', h, w2)
        return out
    x = A_x
    mod = (_silu(c) @ w_mod).reshape(c.shape[0], 6, 1, -1)
    sa, ca, ga, sb, cb, gb = (mod[:, 0].clone(), mod[:, 1].clone(), mod[:, 2].clone(), mod[:, 3].clone(), mod[:, 4].clone(), mod[:, 5].clone())
    h = _layernorm(x, axis=-1) * (1 + ca) + sa
    x = x + ga * _A_ref(h, A_k_cache, A_v_cache, A_wq, A_wo)
    h = _layernorm(x, axis=-1) * (1 + cb) + sb
    x = x + gb * _B_ref(h, B_w1, B_w3, B_w2)
    return x
```

```asm
; @launch grid=(256,1,1) block=(1024,1,1) lds=160128
.amdgcn_target "amdgcn-amd-amdhsa--gfx950"
.text
.globl adaLN_cond__sliding_block_cached__glu_gated_swiglu__decode_kernel
.p2align 8
.type adaLN_cond__sliding_block_cached__glu_gated_swiglu__decode_kernel,@function
adaLN_cond__sliding_block_cached__glu_gated_swiglu__decode_kernel:
    s_cmp_ge_u32 s2, 256
    s_cbranch_scc1 L_end
    v_lshrrev_b32 v2, 6, v0
    v_and_b32 v1, 63, v0
    v_readfirstlane_b32 s45, v2
    v_mov_b32 v9, 160000
    v_mov_b32 v15, 1
    s_cmp_lg_u32 s45, 15
    s_cbranch_scc1 L_noinit
    v_lshlrev_b32 v12, 2, v1
    v_and_b32 v12, 127, v12
    v_add_u32 v12, 160000, v12
    v_mov_b32 v13, 0
    ds_write_b32 v12, v13
    s_waitcnt lgkmcnt(0)
L_noinit:
    s_load_dwordx16 s[16:31], s[0:1], 0
    s_load_dwordx8 s[32:39], s[0:1], 64
    s_load_dwordx4 s[40:43], s[0:1], 96
    s_getpc_b64 s[58:59]
L_pc0:
    v_lshlrev_b32 v12, 7, v0
    v_cmp_gt_u32 vcc, L_codeend-L_pc0-4, v12
    s_and_saveexec_b64 s[60:61], vcc
    s_cbranch_execz L_nopf0
    global_load_dword v127, v12, s[58:59]
L_nopf0:
    s_mov_b64 exec, -1
    s_and_b32 s46, s2, 7
    s_bfe_u32 s47, s2, 0x20003
    s_lshr_b32 s48, s2, 5
    s_mul_i32 s53, s48, 3
    s_add_u32 s53, s53, s47
    s_add_u32 s54, s48, 24
    s_cmp_eq_u32 s47, 3
    s_cselect_b32 s53, s54, s53
    s_sub_u32 s54, s53, 6
    s_cmp_lt_u32 s53, 26
    s_cselect_b32 s52, s54, s53
    s_add_u32 s54, s53, 12
    s_cmp_lt_u32 s53, 14
    s_cselect_b32 s52, s54, s52
    s_cmp_lt_u32 s53, 8
    s_cselect_b32 s52, s53, s52
    s_lshl_b32 s49, s48, 3
    s_add_u32 s49, s49, s46
    s_mov_b32 s3, 0
    s_sub_u32 s53, 25, s52
    s_mul_i32 s53, s53, 7
    s_add_u32 s96, s53, s46
    s_cmp_lt_u32 s52, 26
    s_cselect_b32 s3, 5, s3
    s_cmp_lt_u32 s52, 24
    s_cselect_b32 s3, 4, s3
    s_lshl_b32 s53, s46, 2
    s_and_b32 s54, s52, 3
    s_add_u32 s53, s53, s54
    s_cmp_lt_u32 s52, 20
    s_cselect_b32 s3, 2, s3
    s_cselect_b32 s96, s53, s96
    s_lshl_b32 s53, s46, 3
    s_and_b32 s54, s52, 7
    s_add_u32 s53, s53, s54
    s_cmp_lt_u32 s52, 16
    s_cselect_b32 s3, 1, s3
    s_cselect_b32 s96, s53, s96
    s_cmp_eq_u32 s46, 7
    s_cselect_b32 s3, 0, s3
    s_cmp_lt_u32 s52, 8
    s_cselect_b32 s3, 3, s3
    s_and_b32 s55, s45, 7
    s_lshl_b32 s97, s55, 13
    v_lshrrev_b32 v6, 4, v1
    s_lshl_b32 s53, s55, 2
    v_add_u32 v126, s53, v9
    v_mov_b32 v61, 0
    s_mov_b32 s6, 4194304
    s_mov_b32 s7, 0x20000
    v_lshrrev_b32 v3, 5, v1
    v_and_b32 v2, 31, v1
    v_xor_b32 v2, v2, v3
    v_lshlrev_b32 v2, 4, v2
    v_lshl_add_u32 v2, v3, 9, v2
    s_lshl_b32 s54, s49, 21
    s_lshl_b32 s53, s47, 17
    s_add_u32 s54, s54, s53
    s_add_u32 s54, s54, 1572864
    s_mul_i32 s57, s2, 37
    s_add_u32 s57, s57, s55
    s_and_b32 s101, s57, 7
    s_lshr_b32 s57, s57, 3
    s_lshl_b32 s53, s101, 10
    s_add_u32 s54, s54, s53
    s_mov_b32 s56, 0
    s_mov_b32 s98, s97
    s_mov_b32 s10, 134217728
    s_mov_b32 s11, 0x20000
    s_cmp_lt_u32 s3, 3
    s_cselect_b32 s53, s45, 8
    s_cmp_lt_u32 s53, 8
    s_cbranch_scc1 L_nobar
    s_barrier
L_nobar:
    s_cmp_ge_u32 s45, 8
    s_waitcnt lgkmcnt(0)
    s_mov_b32 s8, s18
    s_mov_b32 s9, s19
    s_load_dword s44, s[42:43], 0
    s_mov_b32 s4, s42
    s_mov_b32 s5, s43
    s_cbranch_scc1 L_vwave
    s_setprio 2
    s_cmp_lt_u32 s3, 4
    s_cbranch_scc1 L_k_noc
    s_mov_b32 s12, s34
    s_mov_b32 s13, s35
    s_mov_b32 s14, 7168
    s_mov_b32 s15, 0x20000
    s_mul_i32 s53, s55, 896
    v_lshlrev_b32 v11, 4, v1
    buffer_load_dwordx4 v[80:83], v11, s[12:15], s53 offen
L_k_noc:
    s_cmp_gt_u32 s55, 0
    s_cbranch_scc1 L_k_nopf
    s_cmp_eq_u32 s55, 0
    s_cselect_b32 s12, s36, s22
    s_cselect_b32 s13, s37, s23
    s_mov_b32 s14, 3670016
    s_cselect_b32 s14, 2408448, s14
    s_mov_b32 s15, 0x20000
    s_movk_i32 s58, 8192
    s_cselect_b32 s58, 5376, s58
    s_movk_i32 s59, 512
    s_cselect_b32 s59, 896, s59
    s_min_u32 s60, s46, 6
    s_lshl_b32 s60, s60, 7
    s_lshl_b32 s61, s46, 10
    s_add_u32 s61, s61, 384
    s_cmp_eq_u32 s55, 0
    s_cselect_b32 s60, s60, s61
    v_and_b32 v10, 15, v1
    v_mul_lo_u32 v10, v10, s58
    v_mad_u32_u24 v10, v6, s59, v10
    s_mul_i32 s53, s52, 14
    s_mul_i32 s53, s53, s58
    s_add_u32 s53, s53, s60
    s_mov_b64 exec, 0x3fff3fff
    buffer_load_dword v127, v10, s[12:15], s53 offen
    s_mov_b64 exec, -1
L_k_nopf:
    s_mov_b64 vcc, 0
    s_cmp_ge_u32 s3, 3
    s_cbranch_scc1 L_k_role
    s_add_u32 s58, s56, s57
    s_and_b32 s58, s58, 7
    s_lshl_b32 s59, s58, 5
    v_xor_b32 v3, s59, v2
    s_lshl_b32 s58, s58, 10
    s_add_u32 m0, s58, s98
    s_lshl_b32 s58, s58, 3
    s_add_u32 s58, s58, s54
    s_add_u32 s56, s56, 1
    buffer_load_dwordx4 v3, s[8:11], s58 offen nt lds
    s_add_u32 s58, s56, s57
    s_and_b32 s58, s58, 7
    s_lshl_b32 s59, s58, 5
    v_xor_b32 v3, s59, v2
    s_lshl_b32 s58, s58, 10
    s_add_u32 m0, s58, s98
    s_lshl_b32 s58, s58, 3
    s_add_u32 s58, s58, s54
    s_add_u32 s56, s56, 1
    buffer_load_dwordx4 v3, s[8:11], s58 offen nt lds
    s_add_u32 s58, s56, s57
    s_and_b32 s58, s58, 7
    s_lshl_b32 s59, s58, 5
    v_xor_b32 v3, s59, v2
    s_lshl_b32 s58, s58, 10
    s_add_u32 m0, s58, s98
    s_lshl_b32 s58, s58, 3
    s_add_u32 s58, s58, s54
    s_add_u32 s56, s56, 1
    buffer_load_dwordx4 v3, s[8:11], s58 offen nt lds
    s_barrier
L_k_k1:
    s_cbranch_vccnz L_k_k1q
    s_waitcnt vmcnt(2)
L_k_k1q:
    s_waitcnt vmcnt(7)
    s_add_u32 s58, s56, s57
    s_and_b32 s58, s58, 7
    s_lshl_b32 s59, s58, 5
    v_xor_b32 v3, s59, v2
    s_lshl_b32 s58, s58, 10
    s_add_u32 m0, s58, s98
    s_lshl_b32 s58, s58, 3
    s_add_u32 s58, s58, s54
    s_add_u32 s56, s56, 1
    buffer_load_dwordx4 v3, s[8:11], s58 offen nt lds
    s_cmp_lt_u32 s56, 8
    s_cbranch_scc1 L_k_k1
    s_add_u32 s98, s97, 65536
    s_add_u32 s54, s54, 65536
    s_cmp_ge_u32 s3, 3
    s_cbranch_scc1 L_k_gate1
L_k_k2:
    s_cbranch_vccnz L_k_k2q
    s_waitcnt vmcnt(2)
L_k_k2q:
    s_waitcnt vmcnt(7)
    s_add_u32 s58, s56, s57
    s_and_b32 s58, s58, 7
    s_lshl_b32 s59, s58, 5
    v_xor_b32 v3, s59, v2
    s_lshl_b32 s58, s58, 10
    s_add_u32 m0, s58, s98
    s_lshl_b32 s58, s58, 3
    s_add_u32 s58, s58, s54
    s_add_u32 s56, s56, 1
    buffer_load_dwordx4 v3, s[8:11], s58 offen nt lds
    s_cmp_lt_u32 s56, 16
    s_cbranch_scc1 L_k_k2
    s_mov_b64 exec, 1
    ds_add_u32 v9, v15 offset:40
    s_mov_b64 exec, -1
    s_waitcnt lgkmcnt(0)
    s_add_u32 s50, s44, 1
    s_mul_i32 s51, s50, 0x9E3779B1
    s_or_b32 s51, s51, 0x80000001
    v_and_b32 v10, 15, v1
    v_xor_b32 v5, v10, v6
    v_lshlrev_b32 v5, 4, v5
    v_lshl_add_u32 v5, v10, 9, v5
    v_xor_b32 v4, 64, v5
    v_xor_b32 v7, 0x80, v5
    v_xor_b32 v8, 0xc0, v5
    v_add_u32 v5, s97, v5
    v_add_u32 v4, s97, v4
    v_add_u32 v7, s97, v7
    v_add_u32 v8, s97, v8
    v_and_b32 v12, 1, v1
    v_lshlrev_b32 v12, 9, v12
    v_lshl_add_u32 v12, v6, 4, v12
    v_add_u32 v12, 154880, v12
    s_waitcnt vmcnt(8)
    ds_read_b128 v[16:19], v5 offset:0
    ds_read_b128 v[20:23], v4 offset:0
    ds_read_b128 v[24:27], v7 offset:0
    ds_read_b128 v[28:31], v8 offset:0
    ds_read_b128 v[32:35], v5 offset:256
    ds_read_b128 v[36:39], v4 offset:256
    ds_read_b128 v[40:43], v7 offset:256
    ds_read_b128 v[44:47], v8 offset:256
    s_waitcnt lgkmcnt(0)
    s_mov_b64 exec, 1
    ds_add_u32 v126, v15 offset:64
    s_mov_b64 exec, -1
    v_add_u32 v5, 0x10000, v5
    v_add_u32 v4, 0x10000, v4
    v_add_u32 v7, 0x10000, v7
    v_add_u32 v8, 0x10000, v8
    s_lshl_b32 s58, s46, 14
    s_lshl_b32 s59, s55, 11
    s_add_u32 s58, s58, s59
    s_lshl_b32 s59, s48, 8
    s_add_u32 s58, s58, s59
    s_add_u32 s58, s58, 131072
    s_add_u32 s60, s4, s58
    s_addc_u32 s61, s5, 0
    v_lshlrev_b32 v11, 3, v1
    s_lshl_b32 s53, s55, 7
    s_add_u32 s53, s53, 154880
    v_add_u32 v11, s53, v11
    s_mov_b32 s62, 1000000
L_k_h2:
    s_branch H2_1c
H2_1:
    s_sleep 2
H2_1c:
    s_load_dwordx16 s[16:31], s[60:61], 0 glc
    s_load_dwordx8 s[8:15], s[60:61], 64 glc
    s_load_dwordx8 s[32:39], s[60:61], 96 glc
    s_load_dwordx16 s[64:79], s[60:61], 128 glc
    s_load_dwordx16 s[80:95], s[60:61], 192 glc
    s_sub_u32 s62, s62, 1
    s_cselect_b32 s63, 0, -1
    s_max_i32 s62, s62, 0
    s_waitcnt lgkmcnt(0)
    s_xor_b32 s56, s29, s31
    s_xor_b32 s56, s56, s51
    s_xor_b32 s57, s37, s39
    s_xor_b32 s57, s57, s51
    s_or_b32 s56, s56, s57
    s_xor_b32 s57, s77, s79
    s_xor_b32 s57, s57, s51
    s_or_b32 s56, s56, s57
    s_xor_b32 s57, s93, s95
    s_xor_b32 s57, s57, s51
    s_or_b32 s56, s56, s57
    s_and_b32 s56, s56, s63
    s_cbranch_scc1 H2_1
    v_writelane_b32 v80, s16, 0
    v_writelane_b32 v81, s17, 0
    v_writelane_b32 v82, s18, 0
    v_writelane_b32 v83, s19, 0
    v_writelane_b32 v80, s20, 1
    v_writelane_b32 v81, s21, 1
    v_writelane_b32 v82, s22, 1
    v_writelane_b32 v83, s23, 1
    v_writelane_b32 v80, s24, 2
    v_writelane_b32 v81, s25, 2
    v_writelane_b32 v82, s26, 2
    v_writelane_b32 v83, s27, 2
    v_writelane_b32 v80, s28, 3
    v_writelane_b32 v81, s29, 3
    v_writelane_b32 v82, s30, 3
    v_writelane_b32 v83, s31, 3
    v_writelane_b32 v80, s8, 4
    v_writelane_b32 v81, s9, 4
    v_writelane_b32 v82, s10, 4
    v_writelane_b32 v83, s11, 4
    v_writelane_b32 v80, s12, 5
    v_writelane_b32 v81, s13, 5
    v_writelane_b32 v82, s14, 5
    v_writelane_b32 v83, s15, 5
    v_writelane_b32 v80, s32, 6
    v_writelane_b32 v81, s33, 6
    v_writelane_b32 v82, s34, 6
    v_writelane_b32 v83, s35, 6
    v_writelane_b32 v80, s36, 7
    v_writelane_b32 v81, s37, 7
    v_writelane_b32 v82, s38, 7
    v_writelane_b32 v83, s39, 7
    v_writelane_b32 v80, s64, 8
    v_writelane_b32 v81, s65, 8
    v_writelane_b32 v82, s66, 8
    v_writelane_b32 v83, s67, 8
    v_writelane_b32 v80, s68, 9
    v_writelane_b32 v81, s69, 9
    v_writelane_b32 v82, s70, 9
    v_writelane_b32 v83, s71, 9
    v_writelane_b32 v80, s72, 10
    v_writelane_b32 v81, s73, 10
    v_writelane_b32 v82, s74, 10
    v_writelane_b32 v83, s75, 10
    v_writelane_b32 v80, s76, 11
    v_writelane_b32 v81, s77, 11
    v_writelane_b32 v82, s78, 11
    v_writelane_b32 v83, s79, 11
    v_writelane_b32 v80, s80, 12
    v_writelane_b32 v81, s81, 12
    v_writelane_b32 v82, s82, 12
    v_writelane_b32 v83, s83, 12
    v_writelane_b32 v80, s84, 13
    v_writelane_b32 v81, s85, 13
    v_writelane_b32 v82, s86, 13
    v_writelane_b32 v83, s87, 13
    v_writelane_b32 v80, s88, 14
    v_writelane_b32 v81, s89, 14
    v_writelane_b32 v82, s90, 14
    v_writelane_b32 v83, s91, 14
    v_writelane_b32 v80, s92, 15
    v_writelane_b32 v81, s93, 15
    v_writelane_b32 v82, s94, 15
    v_writelane_b32 v83, s95, 15
    s_mov_b64 exec, 0xffff
    v_bitop3_b32 v13, v80, v82, s50 bitop3:0x96
    v_bitop3_b32 v14, v81, v83, s51 bitop3:0x96
    v_or_b32 v13, v13, v14
    v_cmp_ne_u32 vcc, 0, v13
    s_and_b32 s56, vcc_lo, s63
    s_cbranch_scc1 L_k_h2
    ds_write_b64 v11, v[80:81]
    s_mov_b64 exec, 1
    ds_add_u32 v9, v15 offset:16
    s_mov_b64 exec, -1
    s_load_dwordx16 s[16:31], s[0:1], 0
    s_load_dwordx8 s[32:39], s[0:1], 64
    s_waitcnt vmcnt(0)
    ds_read_b128 v[48:51], v5 offset:0
    ds_read_b128 v[52:55], v4 offset:0
    ds_read_b128 v[56:59], v7 offset:0
    ds_read_b128 v[60:63], v8 offset:0
    ds_read_b128 v[64:67], v5 offset:256
    ds_read_b128 v[68:71], v4 offset:256
    ds_read_b128 v[72:75], v7 offset:256
    ds_read_b128 v[76:79], v8 offset:256
    s_waitcnt lgkmcnt(0)
    s_mov_b64 exec, 1
    ds_add_u32 v126, v15 offset:64
    s_mov_b64 exec, -1
    s_lshl_b32 s58, s49, 13
    s_lshl_b32 s59, s47, 11
    s_add_u32 s58, s58, s59
    s_lshl_b32 s59, s101, 8
    s_add_u32 s58, s58, s59
    s_add_u32 s58, s58, 262144
    v_lshlrev_b32 v10, 4, v1
    s_lshl_b32 s56, s49, 9
    s_lshl_b32 s59, s47, 7
    s_add_u32 s56, s56, s59
    s_add_u32 s56, s56, 36864
    s_mov_b32 s62, 8000000
LW_2:
LWc_3:
    ds_read_b32 v13, v9 offset:16
    s_sub_u32 s62, s62, 1
    s_cselect_b32 s61, 0, 8
    s_waitcnt lgkmcnt(0)
    v_readfirstlane_b32 s63, v13
    s_nop 0
    s_cmp_lt_u32 s63, s61
    s_cbranch_scc1 LW_2
    ds_read_b128 v[80:83], v12 offset:0
    ds_read_b128 v[84:87], v12 offset:64
    ds_read_b128 v[88:91], v12 offset:128
    ds_read_b128 v[92:95], v12 offset:192
    ds_read_b128 v[96:99], v12 offset:256
    ds_read_b128 v[100:103], v12 offset:320
    ds_read_b128 v[104:107], v12 offset:384
    ds_read_b128 v[108:111], v12 offset:448
    s_waitcnt lgkmcnt(7)
    v_mfma_f32_16x16x32_bf16 v[112:115], v[80:83], v[16:19], 0
    v_mfma_f32_16x16x32_bf16 v[116:119], v[80:83], v[48:51], 0
    s_waitcnt lgkmcnt(6)
    v_mfma_f32_16x16x32_bf16 v[112:115], v[84:87], v[20:23], v[112:115]
    v_mfma_f32_16x16x32_bf16 v[116:119], v[84:87], v[52:55], v[116:119]
    s_waitcnt lgkmcnt(5)
    v_mfma_f32_16x16x32_bf16 v[112:115], v[88:91], v[24:27], v[112:115]
    v_mfma_f32_16x16x32_bf16 v[116:119], v[88:91], v[56:59], v[116:119]
    s_waitcnt lgkmcnt(4)
    v_mfma_f32_16x16x32_bf16 v[112:115], v[92:95], v[28:31], v[112:115]
    v_mfma_f32_16x16x32_bf16 v[116:119], v[92:95], v[60:63], v[116:119]
    s_waitcnt lgkmcnt(3)
    v_mfma_f32_16x16x32_bf16 v[112:115], v[96:99], v[32:35], v[112:115]
    v_mfma_f32_16x16x32_bf16 v[116:119], v[96:99], v[64:67], v[116:119]
    s_waitcnt lgkmcnt(2)
    v_mfma_f32_16x16x32_bf16 v[112:115], v[100:103], v[36:39], v[112:115]
    v_mfma_f32_16x16x32_bf16 v[116:119], v[100:103], v[68:71], v[116:119]
    s_waitcnt lgkmcnt(1)
    v_mfma_f32_16x16x32_bf16 v[112:115], v[104:107], v[40:43], v[112:115]
    v_mfma_f32_16x16x32_bf16 v[116:119], v[104:107], v[72:75], v[116:119]
    s_waitcnt lgkmcnt(0)
    v_mfma_f32_16x16x32_bf16 v[112:115], v[108:111], v[44:47], v[112:115]
    v_mfma_f32_16x16x32_bf16 v[116:119], v[108:111], v[76:79], v[116:119]
    s_nop 6
    v_cvt_pk_bf16_f32 v120, v112, v113
    v_cvt_pk_bf16_f32 v121, v116, v117
    v_xor_b32 v122, s50, v120
    v_xor_b32 v123, s51, v121
    s_mov_b64 exec, 0xffff
    buffer_store_dwordx4 v[120:123], v10, s[4:7], s58 offen sc1
    s_mov_b64 exec, 1
    ds_add_rtn_u32 v11, v9, v15 offset:24
    s_waitcnt lgkmcnt(0)
    v_readfirstlane_b32 s63, v11
    s_nop 0
    s_cmp_lg_u32 s63, 7
    s_cbranch_scc1 L_k_noflag
    buffer_store_dwordx4 v[120:123], v10, s[4:7], s56 offen sc1
L_k_noflag:
    s_mov_b64 exec, -1
    s_cmp_lt_u32 s55, 6
    s_cbranch_scc1 L_k_post
    s_setprio 3
    s_lshl_b32 s63, s49, 9
    s_add_u32 s63, s63, 36864
    s_add_u32 s60, s4, s63
    s_addc_u32 s61, s5, 0
    s_mov_b32 s62, 1000000
    s_branch SGc_5
SG_4:
    s_sleep 2
SGc_5:
    s_load_dwordx4 s[8:11], s[60:61], 0 glc
    s_load_dwordx4 s[12:15], s[60:61], 128 glc
    s_load_dwordx4 s[56:59], s[60:61], 256 glc
    s_load_dwordx4 s[92:95], s[60:61], 384 glc
    s_sub_u32 s62, s62, 1
    s_cselect_b32 s63, 0, -1
    s_waitcnt lgkmcnt(0)
    s_xor_b32 s8, s9, s11
    s_xor_b32 s8, s8, s51
    s_xor_b32 s12, s13, s15
    s_xor_b32 s12, s12, s51
    s_or_b32 s8, s8, s12
    s_xor_b32 s56, s57, s59
    s_xor_b32 s56, s56, s51
    s_or_b32 s8, s8, s56
    s_xor_b32 s92, s93, s95
    s_xor_b32 s92, s92, s51
    s_or_b32 s8, s8, s92
    s_and_b32 s8, s8, s63
    s_cbranch_scc1 SG_4
    s_lshl_b32 s97, s49, 13
    s_add_u32 s97, s97, 262144
    s_add_u32 s98, s97, 4096
    v_lshlrev_b32 v11, 4, v1
    v_bfe_u32 v12, v1, 1, 3
    v_lshlrev_b32 v12, 5, v12
    v_lshl_add_u32 v12, v6, 2, v12
    v_and_b32 v13, 1, v1
    v_lshl_add_u32 v12, v13, 1, v12
    s_sub_u32 s53, 7, s55
    s_lshl_b32 s53, s53, 11
    s_add_u32 s53, s53, 146688
    v_add_u32 v12, s53, v12
    s_sub_u32 s53, s55, 6
    s_lshl_b32 s53, s53, 4
    s_mov_b32 s54, 0xffff0000
    s_mov_b32 s56, 0x3db8aa3b
    s_mov_b32 s57, 0x3db8aa3b
    s_mov_b32 s62, 1000000
G_6:
Gc_7:
    buffer_load_dwordx4 v[16:19], v11, s[4:7], s97 offen offset:0 sc1
    buffer_load_dwordx4 v[20:23], v11, s[4:7], s97 offen offset:1024 sc1
    buffer_load_dwordx4 v[24:27], v11, s[4:7], s97 offen offset:2048 sc1
    buffer_load_dwordx4 v[28:31], v11, s[4:7], s97 offen offset:3072 sc1
    buffer_load_dwordx4 v[32:35], v11, s[4:7], s98 offen offset:0 sc1
    buffer_load_dwordx4 v[36:39], v11, s[4:7], s98 offen offset:1024 sc1
    buffer_load_dwordx4 v[40:43], v11, s[4:7], s98 offen offset:2048 sc1
    buffer_load_dwordx4 v[44:47], v11, s[4:7], s98 offen offset:3072 sc1
    s_sub_u32 s62, s62, 1
    s_cselect_b64 s[60:61], 0, -1
    s_waitcnt vmcnt(7)
    v_bitop3_b32 v14, v16, v18, s50 bitop3:0x96
    v_bitop3_b32 v3, v17, v19, s51 bitop3:0x96
    v_or_b32 v13, v14, v3
    s_waitcnt vmcnt(6)
    v_bitop3_b32 v14, v20, v22, s50 bitop3:0x96
    v_bitop3_b32 v3, v21, v23, s51 bitop3:0x96
    v_or3_b32 v13, v13, v14, v3
    s_waitcnt vmcnt(5)
    v_bitop3_b32 v14, v24, v26, s50 bitop3:0x96
    v_bitop3_b32 v3, v25, v27, s51 bitop3:0x96
    v_or3_b32 v13, v13, v14, v3
    s_waitcnt vmcnt(4)
    v_bitop3_b32 v14, v28, v30, s50 bitop3:0x96
    v_bitop3_b32 v3, v29, v31, s51 bitop3:0x96
    v_or3_b32 v13, v13, v14, v3
    s_waitcnt vmcnt(3)
    v_bitop3_b32 v14, v32, v34, s50 bitop3:0x96
    v_bitop3_b32 v3, v33, v35, s51 bitop3:0x96
    v_or3_b32 v13, v13, v14, v3
    s_waitcnt vmcnt(2)
    v_bitop3_b32 v14, v36, v38, s50 bitop3:0x96
    v_bitop3_b32 v3, v37, v39, s51 bitop3:0x96
    v_or3_b32 v13, v13, v14, v3
    s_waitcnt vmcnt(1)
    v_bitop3_b32 v14, v40, v42, s50 bitop3:0x96
    v_bitop3_b32 v3, v41, v43, s51 bitop3:0x96
    v_or3_b32 v13, v13, v14, v3
    s_waitcnt vmcnt(0)
    v_bitop3_b32 v14, v44, v46, s50 bitop3:0x96
    v_bitop3_b32 v3, v45, v47, s51 bitop3:0x96
    v_or3_b32 v13, v13, v14, v3
    v_cmp_ne_u32 vcc, 0, v13
    s_and_b64 vcc, vcc, s[60:61]
    s_cbranch_scc1 G_6
    v_lshlrev_b32 v18, s53, v16
    v_lshlrev_b32 v19, s53, v17
    v_lshlrev_b32 v22, s53, v20
    v_lshlrev_b32 v23, s53, v21
    v_lshlrev_b32 v26, s53, v24
    v_lshlrev_b32 v27, s53, v25
    v_lshlrev_b32 v30, s53, v28
    v_lshlrev_b32 v31, s53, v29
    v_lshlrev_b32 v34, s53, v32
    v_lshlrev_b32 v35, s53, v33
    v_lshlrev_b32 v38, s53, v36
    v_lshlrev_b32 v39, s53, v37
    v_lshlrev_b32 v42, s53, v40
    v_lshlrev_b32 v43, s53, v41
    v_lshlrev_b32 v46, s53, v44
    v_lshlrev_b32 v47, s53, v45
    v_and_b32 v18, s54, v18
    v_and_b32 v19, s54, v19
    v_and_b32 v22, s54, v22
    v_and_b32 v23, s54, v23
    v_and_b32 v26, s54, v26
    v_and_b32 v27, s54, v27
    v_and_b32 v30, s54, v30
    v_and_b32 v31, s54, v31
    v_and_b32 v34, s54, v34
    v_and_b32 v35, s54, v35
    v_and_b32 v38, s54, v38
    v_and_b32 v39, s54, v39
    v_and_b32 v42, s54, v42
    v_and_b32 v43, s54, v43
    v_and_b32 v46, s54, v46
    v_and_b32 v47, s54, v47
    v_max3_f32 v64, v18, v19, v22
    v_max3_f32 v66, v23, v26, v27
    v_max3_f32 v64, v64, v30, v31
    v_max3_f32 v66, v66, v34, v35
    v_max3_f32 v64, v64, v38, v39
    v_max3_f32 v66, v66, v42, v43
    v_max3_f32 v64, v64, v46, v47
    v_max_f32 v64, v64, v66
    s_nop 1
    v_max_f32_dpp v64, v64, v64 quad_perm:[1,0,3,2] row_mask:0xf bank_mask:0xf
    s_nop 1
    v_max_f32_dpp v64, v64, v64 quad_perm:[2,3,0,1] row_mask:0xf bank_mask:0xf
    s_nop 1
    v_max_f32_dpp v64, v64, v64 row_half_mirror row_mask:0xf bank_mask:0xf
    s_nop 1
    v_max_f32_dpp v64, v64, v64 row_mirror row_mask:0xf bank_mask:0xf
    v_mov_b32 v65, v64
    s_nop 1
    v_permlane16_swap_b32 v65, v64
    v_max_f32 v64, v64, v65
    v_mov_b32 v65, v64
    s_nop 1
    v_permlane32_swap_b32 v65, v64
    v_max_f32 v64, v64, v65
    v_pk_add_f32 v[18:19], v[18:19], v[64:65] op_sel_hi:[1,0] neg_lo:[0,1] neg_hi:[0,1]
    v_pk_add_f32 v[22:23], v[22:23], v[64:65] op_sel_hi:[1,0] neg_lo:[0,1] neg_hi:[0,1]
    v_pk_add_f32 v[26:27], v[26:27], v[64:65] op_sel_hi:[1,0] neg_lo:[0,1] neg_hi:[0,1]
    v_pk_add_f32 v[30:31], v[30:31], v[64:65] op_sel_hi:[1,0] neg_lo:[0,1] neg_hi:[0,1]
    v_pk_add_f32 v[34:35], v[34:35], v[64:65] op_sel_hi:[1,0] neg_lo:[0,1] neg_hi:[0,1]
    v_pk_add_f32 v[38:39], v[38:39], v[64:65] op_sel_hi:[1,0] neg_lo:[0,1] neg_hi:[0,1]
    v_pk_add_f32 v[42:43], v[42:43], v[64:65] op_sel_hi:[1,0] neg_lo:[0,1] neg_hi:[0,1]
    v_pk_add_f32 v[46:47], v[46:47], v[64:65] op_sel_hi:[1,0] neg_lo:[0,1] neg_hi:[0,1]
    v_pk_mul_f32 v[18:19], v[18:19], s[56:57]
    v_pk_mul_f32 v[22:23], v[22:23], s[56:57]
    v_pk_mul_f32 v[26:27], v[26:27], s[56:57]
    v_pk_mul_f32 v[30:31], v[30:31], s[56:57]
    v_pk_mul_f32 v[34:35], v[34:35], s[56:57]
    v_pk_mul_f32 v[38:39], v[38:39], s[56:57]
    v_pk_mul_f32 v[42:43], v[42:43], s[56:57]
    v_pk_mul_f32 v[46:47], v[46:47], s[56:57]
    v_exp_f32 v18, v18
    v_exp_f32 v19, v19
    v_exp_f32 v22, v22
    v_exp_f32 v23, v23
    v_exp_f32 v26, v26
    v_exp_f32 v27, v27
    v_exp_f32 v30, v30
    v_exp_f32 v31, v31
    v_exp_f32 v34, v34
    v_exp_f32 v35, v35
    v_exp_f32 v38, v38
    v_exp_f32 v39, v39
    v_exp_f32 v42, v42
    v_exp_f32 v43, v43
    v_exp_f32 v46, v46
    v_exp_f32 v47, v47
    v_pk_add_f32 v[64:65], v[18:19], v[22:23]
    v_pk_add_f32 v[66:67], v[26:27], v[30:31]
    v_pk_add_f32 v[64:65], v[64:65], v[34:35]
    v_pk_add_f32 v[66:67], v[66:67], v[38:39]
    v_pk_add_f32 v[64:65], v[64:65], v[42:43]
    v_pk_add_f32 v[66:67], v[66:67], v[46:47]
    v_pk_add_f32 v[64:65], v[64:65], v[66:67]
    v_add_f32 v64, v64, v65
    s_nop 1
    v_add_f32_dpp v64, v64, v64 quad_perm:[1,0,3,2] row_mask:0xf bank_mask:0xf
    s_nop 1
    v_add_f32_dpp v64, v64, v64 quad_perm:[2,3,0,1] row_mask:0xf bank_mask:0xf
    s_nop 1
    v_add_f32_dpp v64, v64, v64 row_half_mirror row_mask:0xf bank_mask:0xf
    s_nop 1
    v_add_f32_dpp v64, v64, v64 row_mirror row_mask:0xf bank_mask:0xf
    v_mov_b32 v65, v64
    s_nop 1
    v_permlane16_swap_b32 v65, v64
    v_add_f32 v64, v64, v65
    v_mov_b32 v65, v64
    s_nop 1
    v_permlane32_swap_b32 v65, v64
    v_add_f32 v64, v64, v65
    v_rcp_f32 v64, v64
    s_nop 0
    v_pk_mul_f32 v[18:19], v[18:19], v[64:65] op_sel_hi:[1,0]
    v_pk_mul_f32 v[22:23], v[22:23], v[64:65] op_sel_hi:[1,0]
    v_pk_mul_f32 v[26:27], v[26:27], v[64:65] op_sel_hi:[1,0]
    v_pk_mul_f32 v[30:31], v[30:31], v[64:65] op_sel_hi:[1,0]
    v_pk_mul_f32 v[34:35], v[34:35], v[64:65] op_sel_hi:[1,0]
    v_pk_mul_f32 v[38:39], v[38:39], v[64:65] op_sel_hi:[1,0]
    v_pk_mul_f32 v[42:43], v[42:43], v[64:65] op_sel_hi:[1,0]
    v_pk_mul_f32 v[46:47], v[46:47], v[64:65] op_sel_hi:[1,0]
    v_cvt_pk_bf16_f32 v18, v18, v19
    ds_write_b16 v12, v18 offset:0
    ds_write_b16_d16_hi v12, v18 offset:256
    v_cvt_pk_bf16_f32 v22, v22, v23
    ds_write_b16 v12, v22 offset:16
    ds_write_b16_d16_hi v12, v22 offset:272
    v_cvt_pk_bf16_f32 v26, v26, v27
    ds_write_b16 v12, v26 offset:512
    ds_write_b16_d16_hi v12, v26 offset:768
    v_cvt_pk_bf16_f32 v30, v30, v31
    ds_write_b16 v12, v30 offset:528
    ds_write_b16_d16_hi v12, v30 offset:784
    v_cvt_pk_bf16_f32 v34, v34, v35
    ds_write_b16 v12, v34 offset:1024
    ds_write_b16_d16_hi v12, v34 offset:1280
    v_cvt_pk_bf16_f32 v38, v38, v39
    ds_write_b16 v12, v38 offset:1040
    ds_write_b16_d16_hi v12, v38 offset:1296
    v_cvt_pk_bf16_f32 v42, v42, v43
    ds_write_b16 v12, v42 offset:1536
    ds_write_b16_d16_hi v12, v42 offset:1792
    v_cvt_pk_bf16_f32 v46, v46, v47
    ds_write_b16 v12, v46 offset:1552
    ds_write_b16_d16_hi v12, v46 offset:1808
    s_mov_b64 exec, 1
    ds_add_u32 v9, v15 offset:20
    s_mov_b64 exec, -1
    s_cmp_lg_u32 s55, 7
    s_cbranch_scc1 L_k_post
    s_cmp_eq_u32 s3, 1
    s_cbranch_scc1 L_k_late
    s_cmp_eq_u32 s3, 2
    s_cbranch_scc1 L_k7_fin
    s_add_u32 s54, s52, 12
    s_and_b32 s54, s54, 31
    s_cmp_ge_u32 s54, 14
    s_cbranch_scc1 L_fin
    v_and_b32 v12, 15, v1
    s_mov_b32 s8, s16
    s_mov_b32 s9, s17
    s_mov_b32 s10, 7168
    s_mov_b32 s11, 0x20000
    s_mul_i32 s58, s46, 896
    s_lshl_b32 s59, s54, 6
    s_add_u32 s58, s58, s59
    v_lshlrev_b32 v13, 2, v12
    buffer_load_dword v72, v13, s[8:11], s58 offen
    v_lshrrev_b32 v13, 1, v12
    v_lshlrev_b32 v13, 4, v13
    s_lshr_b32 s58, s54, 1
    s_lshl_b32 s58, s58, 11
    s_lshl_b32 s59, s46, 8
    s_add_u32 s58, s58, s59
    s_and_b32 s59, s54, 1
    s_lshl_b32 s59, s59, 7
    s_add_u32 s58, s58, s59
    s_add_u32 s58, s58, 2191360
    s_mov_b32 s62, 1000000
    s_branch Gc_9
G_8:
    s_sleep 2
Gc_9:
    buffer_load_dwordx4 v[76:79], v13, s[4:7], s58 offen offset:0 sc1
    s_sub_u32 s62, s62, 1
    s_cselect_b64 s[60:61], 0, -1
    s_waitcnt vmcnt(0)
    v_bitop3_b32 v14, v76, v78, s50 bitop3:0x96
    v_bitop3_b32 v3, v77, v79, s51 bitop3:0x96
    v_or_b32 v48, v14, v3
    v_cmp_ne_u32 vcc, 0, v48
    s_and_b64 vcc, vcc, s[60:61]
    s_cbranch_scc1 G_8
    v_and_b32 v14, 1, v1
    v_cmp_ne_u32 vcc, 0, v14
    s_mul_i32 s97, s46, 14
    s_add_u32 s97, s97, s54
    v_cndmask_b32 v76, v76, v77, vcc
    v_lshlrev_b32 v68, 16, v76
    v_and_b32 v69, 0xffff0000, v76
    v_lshlrev_b32 v70, 16, v72
    v_and_b32 v71, 0xffff0000, v72
    s_lshl_b32 s97, s97, 13
    s_add_u32 s97, s97, 1048576
    s_add_u32 s98, s97, 4096
    s_mul_i32 s59, s46, 1792
    s_lshl_b32 s58, s54, 7
    s_add_u32 s59, s59, s58
    s_add_u32 s59, s59, 20480
    s_barrier
    s_mov_b32 s62, 1000000
G_10:
Gc_11:
    buffer_load_dwordx4 v[16:19], v11, s[4:7], s97 offen offset:0 sc1
    buffer_load_dwordx4 v[20:23], v11, s[4:7], s97 offen offset:1024 sc1
    buffer_load_dwordx4 v[24:27], v11, s[4:7], s97 offen offset:2048 sc1
    buffer_load_dwordx4 v[28:31], v11, s[4:7], s97 offen offset:3072 sc1
    buffer_load_dwordx4 v[32:35], v11, s[4:7], s98 offen offset:0 sc1
    buffer_load_dwordx4 v[36:39], v11, s[4:7], s98 offen offset:1024 sc1
    buffer_load_dwordx4 v[40:43], v11, s[4:7], s98 offen offset:2048 sc1
    buffer_load_dwordx4 v[44:47], v11, s[4:7], s98 offen offset:3072 sc1
    s_sub_u32 s62, s62, 1
    s_cselect_b64 s[60:61], 0, -1
    s_waitcnt vmcnt(7)
    v_bitop3_b32 v14, v16, v18, s50 bitop3:0x96
    v_bitop3_b32 v3, v17, v19, s51 bitop3:0x96
    v_or_b32 v74, v14, v3
    s_waitcnt vmcnt(6)
    v_bitop3_b32 v14, v20, v22, s50 bitop3:0x96
    v_bitop3_b32 v3, v21, v23, s51 bitop3:0x96
    v_or3_b32 v74, v74, v14, v3
    s_waitcnt vmcnt(5)
    v_bitop3_b32 v14, v24, v26, s50 bitop3:0x96
    v_bitop3_b32 v3, v25, v27, s51 bitop3:0x96
    v_or3_b32 v74, v74, v14, v3
    s_waitcnt vmcnt(4)
    v_bitop3_b32 v14, v28, v30, s50 bitop3:0x96
    v_bitop3_b32 v3, v29, v31, s51 bitop3:0x96
    v_or3_b32 v74, v74, v14, v3
    s_waitcnt vmcnt(3)
    v_bitop3_b32 v14, v32, v34, s50 bitop3:0x96
    v_bitop3_b32 v3, v33, v35, s51 bitop3:0x96
    v_or3_b32 v74, v74, v14, v3
    s_waitcnt vmcnt(2)
    v_bitop3_b32 v14, v36, v38, s50 bitop3:0x96
    v_bitop3_b32 v3, v37, v39, s51 bitop3:0x96
    v_or3_b32 v74, v74, v14, v3
    s_waitcnt vmcnt(1)
    v_bitop3_b32 v14, v40, v42, s50 bitop3:0x96
    v_bitop3_b32 v3, v41, v43, s51 bitop3:0x96
    v_or3_b32 v74, v74, v14, v3
    s_waitcnt vmcnt(0)
    v_bitop3_b32 v14, v44, v46, s50 bitop3:0x96
    v_bitop3_b32 v3, v45, v47, s51 bitop3:0x96
    v_or3_b32 v74, v74, v14, v3
    v_cmp_ne_u32 vcc, 0, v74
    s_and_b64 vcc, vcc, s[60:61]
    s_cbranch_scc1 G_10
    v_pk_add_f32 v[16:17], v[16:17], v[32:33]
    v_pk_add_f32 v[20:21], v[20:21], v[36:37]
    v_pk_add_f32 v[24:25], v[24:25], v[40:41]
    v_pk_add_f32 v[28:29], v[28:29], v[44:45]
    v_pk_add_f32 v[16:17], v[16:17], v[24:25]
    v_pk_add_f32 v[20:21], v[20:21], v[28:29]
    v_pk_add_f32 v[16:17], v[16:17], v[20:21]
    v_mov_b32 v18, v16
    v_mov_b32 v19, v17
    s_nop 0
    v_permlane16_swap_b32 v18, v16
    v_permlane16_swap_b32 v19, v17
    v_pk_add_f32 v[16:17], v[16:17], v[18:19]
    v_mov_b32 v18, v16
    v_mov_b32 v19, v17
    s_nop 0
    v_permlane32_swap_b32 v18, v16
    v_permlane32_swap_b32 v19, v17
    v_pk_add_f32 v[16:17], v[16:17], v[18:19]
    v_cvt_pk_bf16_f32 v3, v16, v17
    v_lshlrev_b32 v16, 16, v3
    v_and_b32 v17, 0xffff0000, v3
    v_pk_mul_f32 v[16:17], v[16:17], v[68:69]
    v_cvt_pk_bf16_f32 v3, v16, v17
    v_lshlrev_b32 v16, 16, v3
    v_and_b32 v17, 0xffff0000, v3
    v_pk_add_f32 v[16:17], v[16:17], v[70:71]
    v_cvt_pk_bf16_f32 v20, v16, v17
    v_xor_b32 v22, s50, v20
    s_nop 0
    v_mov_b32_dpp v21, v20 quad_perm:[1,1,3,3] row_mask:0xf bank_mask:0xf
    s_mov_b64 exec, 0x5555
    v_xor_b32 v23, s51, v21
    buffer_store_dwordx4 v[20:23], v13, s[4:7], s59 offen sc1
    s_branch L_fin
L_k7_fin:
    v_lshrrev_b32 v12, 3, v1
    v_bfe_u32 v13, v1, 1, 2
    v_lshlrev_b32 v13, 4, v13
    v_lshl_add_u32 v10, v12, 8, v13
    s_lshr_b32 s58, s96, 2
    s_add_u32 s58, s58, 35
    s_lshl_b32 s58, s58, 11
    s_and_b32 s59, s96, 3
    s_lshl_b32 s59, s59, 6
    s_add_u32 s58, s58, s59
    s_add_u32 s58, s58, 2162688
    s_mov_b32 s62, 1000000
    s_branch Gc_13
G_12:
    s_sleep 2
Gc_13:
    buffer_load_dwordx4 v[76:79], v10, s[4:7], s58 offen offset:0 sc1
    s_sub_u32 s62, s62, 1
    s_cselect_b64 s[60:61], 0, -1
    s_waitcnt vmcnt(0)
    v_bitop3_b32 v14, v76, v78, s50 bitop3:0x96
    v_bitop3_b32 v3, v77, v79, s51 bitop3:0x96
    v_or_b32 v48, v14, v3
    v_cmp_ne_u32 vcc, 0, v48
    s_and_b64 vcc, vcc, s[60:61]
    s_cbranch_scc1 G_12
    v_and_b32 v14, 1, v1
    v_cmp_ne_u32 vcc, 0, v14
    v_lshlrev_b32 v60, 3, v1
    v_add_u32 v60, 150784, v60
    v_cndmask_b32 v76, v76, v77, vcc
    v_lshlrev_b32 v56, 16, v76
    v_and_b32 v57, 0xffff0000, v76
    v_lshrrev_b32 v61, 3, v1
    v_mul_u32_u24 v61, 896, v61
    v_and_b32 v11, 7, v1
    v_lshl_add_u32 v61, v11, 2, v61
    s_lshl_b32 s97, s96, 5
    s_branch L_k_late
L_k_post:
    s_setprio 0
    s_sub_u32 s53, s3, 1
    s_cmp_lt_u32 s53, 2
    s_cbranch_scc1 L_k_late
    s_cmp_gt_u32 s55, 2
    s_cbranch_scc1 L_fin
    s_cmp_eq_u32 s46, 7
    s_cbranch_scc1 L_fin
L_k_late:
    s_setprio 1
    v_and_b32 v13, 3, v1
    s_cmp_eq_u32 s55, 0
    s_cselect_b32 s8, s28, s30
    s_cselect_b32 s9, s29, s31
    s_mov_b32 s10, 1605632
    s_mov_b32 s11, 0x20000
    v_lshrrev_b32 v12, 2, v1
    v_mul_u32_u24 v12, 3584, v12
    v_lshl_add_u32 v12, v13, 7, v12
    s_mul_i32 s58, s52, 50176
    s_lshl_b32 s59, s46, 9
    s_cmp_lg_u32 s55, 2
    s_cbranch_scc1 L_k_lpf
    s_mov_b32 s8, s32
    s_mov_b32 s9, s33
    v_mul_u32_u24 v12, 896, v1
    s_mul_i32 s58, s52, 50176
    s_lshl_b32 s59, s46, 7
L_k_lpf:
    s_add_u32 s58, s58, s59
    s_barrier
    s_mov_b32 s62, 8000000
    s_branch LWc_15
LW_14:
    s_sleep 1
LWc_15:
    ds_read_b32 v3, v9 offset:48
    s_sub_u32 s62, s62, 1
    s_cselect_b32 s61, 0, 7
    s_waitcnt lgkmcnt(0)
    v_readfirstlane_b32 s63, v3
    s_nop 0
    s_cmp_lt_u32 s63, s61
    s_cbranch_scc1 LW_14
    s_cmp_gt_u32 s55, 2
    s_cbranch_scc1 L_role_load
    s_mov_b32 exec_lo, -1
    s_mov_b32 exec_hi, 0x00ffffff
    buffer_load_dword v127, v12, s[8:11], s58 offen
    s_mov_b64 exec, -1
    s_sub_u32 s53, s3, 1
    s_cmp_ge_u32 s53, 2
    s_cbranch_scc1 L_fin
    s_branch L_role_load
L_k_role:
    s_cmp_lg_u32 s3, 4
    s_cselect_b64 vcc, -1, 0
    s_cmp_lg_u32 s3, 3
    s_cbranch_scc1 L_k_mod
    s_mov_b32 s62, 8000000
    s_branch LWc_17
LW_16:
    s_sleep 1
LWc_17:
    ds_read_b32 v10, v9 offset:36
    s_sub_u32 s62, s62, 1
    s_cselect_b32 s61, 0, 8
    s_waitcnt lgkmcnt(0)
    v_readfirstlane_b32 s63, v10
    s_nop 0
    s_cmp_lt_u32 s63, s61
    s_cbranch_scc1 LW_16
    s_branch L_k_k1
L_k_mod:
    s_mul_i32 s53, s55, 1056
    s_add_u32 s53, s53, 138240
    v_add_u32 v11, s53, v11
    s_cmp_eq_u32 s3, 5
    s_cbranch_scc1 L_k_mu
    s_add_u32 s58, s56, s57
    s_and_b32 s58, s58, 7
    s_lshl_b32 s59, s58, 5
    v_xor_b32 v3, s59, v2
    s_lshl_b32 s58, s58, 10
    s_add_u32 m0, s58, s98
    s_lshl_b32 s58, s58, 3
    s_add_u32 s58, s58, s54
    s_add_u32 s56, s56, 1
    buffer_load_dwordx4 v3, s[8:11], s58 offen nt lds
    s_add_u32 s58, s56, s57
    s_and_b32 s58, s58, 7
    s_lshl_b32 s59, s58, 5
    v_xor_b32 v3, s59, v2
    s_lshl_b32 s58, s58, 10
    s_add_u32 m0, s58, s98
    s_lshl_b32 s58, s58, 3
    s_add_u32 s58, s58, s54
    s_add_u32 s56, s56, 1
    buffer_load_dwordx4 v3, s[8:11], s58 offen nt lds
    s_add_u32 s58, s56, s57
    s_and_b32 s58, s58, 7
    s_lshl_b32 s59, s58, 5
    v_xor_b32 v3, s59, v2
    s_lshl_b32 s58, s58, 10
    s_add_u32 m0, s58, s98
    s_lshl_b32 s58, s58, 3
    s_add_u32 s58, s58, s54
    s_add_u32 s56, s56, 1
    buffer_load_dwordx4 v3, s[8:11], s58 offen nt lds
    s_waitcnt vmcnt(3)
    s_branch L_k_silu
L_k_mu:
    s_waitcnt vmcnt(0)
L_k_silu:
    s_mov_b32 exec_lo, -1
    s_mov_b32 exec_hi, 0x00ffffff
    v_lshlrev_b32 v88, 16, v80
    v_and_b32 v89, 0xffff0000, v80
    v_lshlrev_b32 v90, 16, v81
    v_and_b32 v91, 0xffff0000, v81
    v_lshlrev_b32 v92, 16, v82
    v_and_b32 v93, 0xffff0000, v82
    v_lshlrev_b32 v94, 16, v83
    v_and_b32 v95, 0xffff0000, v83
    v_mul_f32 v96, 0xbfb8aa3b, v88
    v_mul_f32 v99, 0xbfb8aa3b, v89
    v_mul_f32 v102, 0xbfb8aa3b, v90
    v_mul_f32 v105, 0xbfb8aa3b, v91
    v_mul_f32 v108, 0xbfb8aa3b, v92
    v_mul_f32 v111, 0xbfb8aa3b, v93
    v_mul_f32 v114, 0xbfb8aa3b, v94
    v_mul_f32 v117, 0xbfb8aa3b, v95
    v_exp_f32 v96, v96
    v_exp_f32 v99, v99
    v_exp_f32 v102, v102
    v_exp_f32 v105, v105
    v_exp_f32 v108, v108
    v_exp_f32 v111, v111
    v_exp_f32 v114, v114
    v_exp_f32 v117, v117
    v_add_f32 v96, 1.0, v96
    v_add_f32 v99, 1.0, v99
    v_add_f32 v102, 1.0, v102
    v_add_f32 v105, 1.0, v105
    v_add_f32 v108, 1.0, v108
    v_add_f32 v111, 1.0, v111
    v_add_f32 v114, 1.0, v114
    v_add_f32 v117, 1.0, v117
    v_min_f32 v96, 0x7e000000, v96
    v_min_f32 v99, 0x7e000000, v99
    v_min_f32 v102, 0x7e000000, v102
    v_min_f32 v105, 0x7e000000, v105
    v_min_f32 v108, 0x7e000000, v108
    v_min_f32 v111, 0x7e000000, v111
    v_min_f32 v114, 0x7e000000, v114
    v_min_f32 v117, 0x7e000000, v117
    v_rcp_f32 v97, v96
    v_rcp_f32 v100, v99
    v_rcp_f32 v103, v102
    v_rcp_f32 v106, v105
    v_rcp_f32 v109, v108
    v_rcp_f32 v112, v111
    v_rcp_f32 v115, v114
    v_rcp_f32 v118, v117
    v_mul_f32 v98, v88, v97
    v_mul_f32 v101, v89, v100
    v_mul_f32 v104, v90, v103
    v_mul_f32 v107, v91, v106
    v_mul_f32 v110, v92, v109
    v_mul_f32 v113, v93, v112
    v_mul_f32 v116, v94, v115
    v_mul_f32 v119, v95, v118
    v_fma_f32 v96, -v98, v96, v88
    v_fma_f32 v99, -v101, v99, v89
    v_fma_f32 v102, -v104, v102, v90
    v_fma_f32 v105, -v107, v105, v91
    v_fma_f32 v108, -v110, v108, v92
    v_fma_f32 v111, -v113, v111, v93
    v_fma_f32 v114, -v116, v114, v94
    v_fma_f32 v117, -v119, v117, v95
    v_fma_f32 v88, v96, v97, v98
    v_fma_f32 v89, v99, v100, v101
    v_fma_f32 v90, v102, v103, v104
    v_fma_f32 v91, v105, v106, v107
    v_fma_f32 v92, v108, v109, v110
    v_fma_f32 v93, v111, v112, v113
    v_fma_f32 v94, v114, v115, v116
    v_fma_f32 v95, v117, v118, v119
    v_cvt_pk_bf16_f32 v80, v88, v89
    v_cvt_pk_bf16_f32 v81, v90, v91
    v_cvt_pk_bf16_f32 v82, v92, v93
    v_cvt_pk_bf16_f32 v83, v94, v95
    ds_write_b128 v11, v[80:83]
    s_mov_b64 exec, 1
    ds_add_u32 v9, v15 offset:0
    s_mov_b64 exec, -1
    s_cmp_lg_u32 s3, 5
    s_cbranch_scc1 L_k_k1
    s_mov_b32 s62, 8000000
    s_branch LWc_19
LW_18:
    s_sleep 2
LWc_19:
    ds_read_b32 v10, v9 offset:4
    s_sub_u32 s62, s62, 1
    s_cselect_b32 s61, 0, 4
    s_waitcnt lgkmcnt(0)
    v_readfirstlane_b32 s63, v10
    s_nop 0
    s_cmp_lt_u32 s63, s61
    s_cbranch_scc1 LW_18
    s_branch L_k_k1
L_k_gate1:
    s_mov_b64 vcc, -1
    s_cmp_eq_u32 s3, 3
    s_cbranch_scc1 L_k_gate1q
    s_mov_b32 s62, 8000000
    s_branch LWc_21
LW_20:
    s_sleep 2
LWc_21:
    ds_read_b32 v10, v9 offset:12
    s_sub_u32 s62, s62, 1
    s_cselect_b32 s61, 0, 4
    s_waitcnt lgkmcnt(0)
    v_readfirstlane_b32 s63, v10
    s_nop 0
    s_cmp_lt_u32 s63, s61
    s_cbranch_scc1 LW_20
    s_branch L_k_k2
L_k_gate1q:
    s_mov_b32 s62, 8000000
    s_branch LWc_23
LW_22:
    s_sleep 2
LWc_23:
    ds_read_b32 v10, v9 offset:4
    s_sub_u32 s62, s62, 1
    s_cselect_b32 s61, 0, 4
    s_waitcnt lgkmcnt(0)
    v_readfirstlane_b32 s63, v10
    s_nop 0
    s_cmp_lt_u32 s63, s61
    s_cbranch_scc1 LW_22
    s_branch L_k_k2
L_vwave:
    s_setprio 3
    s_cmp_ge_u32 s3, 3
    s_cbranch_scc1 L_role_load
    s_cmp_lg_u32 s55, 7
    s_cbranch_scc1 L_v_main
    s_sub_u32 s53, s52, 8
    s_sub_u32 s59, s52, 14
    s_cmp_lt_u32 s52, 20
    s_cselect_b32 s53, s53, s59
    s_sub_u32 s59, s52, 20
    s_cmp_lt_u32 s59, 6
    s_cbranch_scc1 L_v_main
    s_cmp_ge_u32 s53, 16
    s_cbranch_scc1 L_v_main
    s_mov_b32 s12, s22
    s_mov_b32 s13, s23
    s_mov_b32 s14, 3670016
    s_mov_b32 s15, 0x20000
    v_lshrrev_b32 v10, 1, v1
    v_lshlrev_b32 v10, 13, v10
    v_and_b32 v11, 1, v1
    v_lshl_add_u32 v10, v11, 9, v10
    s_mul_i32 s53, s53, 229376
    s_lshl_b32 s59, s46, 10
    s_add_u32 s53, s53, s59
    s_mov_b32 exec_lo, -1
    s_mov_b32 exec_hi, 0x00ffffff
    buffer_load_dword v16, v10, s[12:15], s53 offen offset:384
    s_mov_b64 exec, -1
    s_branch L_v_main
L_role_load:
    v_lshrrev_b32 v2, 3, v1
    v_and_b32 v3, 7, v1
    v_lshlrev_b32 v3, 4, v3
    v_bfe_u32 v4, v1, 4, 1
    v_lshlrev_b32 v4, 5, v4
    v_xor_b32 v3, v3, v4
    s_and_b32 s53, s55, 1
    s_lshl_b32 s53, s53, 6
    v_xor_b32 v3, s53, v3
    s_lshl_b32 s60, s55, 10
    s_add_u32 s60, s60, 65536
    s_cmp_lt_u32 s3, 3
    s_cbranch_scc1 L_r_late
    s_cmp_eq_u32 s3, 3
    s_cselect_b32 s8, s22, s36
    s_cselect_b32 s9, s23, s37
    s_mov_b32 s10, 2408448
    s_cselect_b32 s10, 3670016, s10
    s_mov_b32 s11, 0x20000
    s_movk_i32 s56, 5376
    s_cselect_b32 s56, 8192, s56
    s_lshl_b32 s57, s96, 7
    v_mul_lo_u32 v2, v2, s56
    v_add_u32 v2, v2, v3
    s_lshl_b32 s58, s56, 3
    s_mul_i32 s58, s58, s55
    s_add_u32 s58, s58, s57
    s_lshl_b32 s59, s56, 6
    s_mov_b32 s12, s16
    s_mov_b32 s13, s17
    s_mov_b32 s14, 7168
    s_mov_b32 s15, 0x20000
    s_mul_i32 s53, s55, 896
    v_lshlrev_b32 v10, 4, v1
    buffer_load_dwordx4 v[80:83], v10, s[12:15], s53 offen
L_r_go1:
    s_movk_i32 s57, 0x2000
L_r_go2:
    s_mov_b32 m0, s60
    s_add_u32 s60, s60, s57
    buffer_load_dwordx4 v2, s[8:11], s58 offen lds
    s_add_u32 s58, s58, s59
    s_mov_b32 m0, s60
    s_add_u32 s60, s60, s57
    buffer_load_dwordx4 v2, s[8:11], s58 offen lds
    s_add_u32 s58, s58, s59
    s_mov_b32 m0, s60
    s_add_u32 s60, s60, s57
    buffer_load_dwordx4 v2, s[8:11], s58 offen lds
    s_add_u32 s58, s58, s59
    s_mov_b32 m0, s60
    s_add_u32 s60, s60, s57
    buffer_load_dwordx4 v2, s[8:11], s58 offen lds
    s_add_u32 s58, s58, s59
    s_mov_b32 m0, s60
    s_add_u32 s60, s60, s57
    buffer_load_dwordx4 v2, s[8:11], s58 offen lds
    s_add_u32 s58, s58, s59
    s_mov_b32 m0, s60
    s_add_u32 s60, s60, s57
    buffer_load_dwordx4 v2, s[8:11], s58 offen lds
    s_add_u32 s58, s58, s59
    s_mov_b32 m0, s60
    s_add_u32 s60, s60, s57
    buffer_load_dwordx4 v2, s[8:11], s58 offen lds
    s_add_u32 s58, s58, s59
L_r_issued:
    s_mov_b64 exec, 1
    ds_add_u32 v9, v15 offset:36
    s_mov_b64 exec, -1
    s_waitcnt lgkmcnt(0)
    s_add_u32 s50, s44, 1
    s_mul_i32 s51, s50, 0x9E3779B1
    s_or_b32 s51, s51, 0x80000001
    v_bfe_u32 v10, v1, 2, 2
    v_and_b32 v11, 3, v1
    v_lshlrev_b32 v7, 10, v6
    v_lshl_add_u32 v7, v10, 7, v7
    v_bfe_u32 v10, v1, 3, 2
    v_lshlrev_b32 v10, 5, v10
    s_lshl_b32 s53, s55, 5
    v_lshl_add_u32 v12, v11, 3, s53
    v_and_b32 v13, 1, v1
    v_lshlrev_b32 v13, 3, v13
    v_bfe_u32 v14, v1, 1, 1
    v_lshl_add_u32 v13, v14, 6, v13
    s_lshl_b32 s53, s55, 4
    v_add_u32 v13, s53, v13
    s_cmp_eq_u32 s3, 1
    s_cselect_b64 vcc, -1, 0
    v_and_b32 v14, 7, v1
    v_mul_u32_u24 v5, 1056, v14
    v_cndmask_b32 v12, v12, v13, vcc
    v_xor_b32 v12, v12, v10
    v_add_u32 v7, v7, v12
    v_add_u32 v7, 65536, v7
    v_lshl_add_u32 v5, v6, 4, v5
    v_add_u32 v5, 138240, v5
    v_lshlrev_b32 v8, 8, v14
    v_lshl_add_u32 v8, v6, 4, v8
    v_lshlrev_b32 v13, 4, v14
    v_lshl_add_u32 v13, v6, 7, v13
    v_cndmask_b32 v8, v8, v13, vcc
    s_cmp_eq_u32 s3, 3
    s_mov_b32 s99, 2162688
    s_cselect_b32 s99, 131072, s99
    s_lshl_b32 s53, s96, 11
    s_add_u32 s99, s99, s53
    s_lshl_b32 s53, s55, 6
    s_add_u32 s99, s99, s53
    s_lshl_b32 s53, s96, 10
    s_lshl_b32 s54, s55, 8
    s_add_u32 s53, s53, s54
    s_add_u32 s53, s53, 2097152
    s_cmp_eq_u32 s3, 1
    s_cselect_b32 s99, s53, s99
    s_cmp_lg_u32 s3, 3
    s_cbranch_scc1 L_r_noln
    s_waitcnt vmcnt(7)
    s_mov_b32 exec_lo, -1
    s_mov_b32 exec_hi, 0x00ffffff
    v_lshlrev_b32 v112, 16, v80
    v_and_b32 v113, 0xffff0000, v80
    v_lshlrev_b32 v114, 16, v81
    v_and_b32 v115, 0xffff0000, v81
    v_lshlrev_b32 v116, 16, v82
    v_and_b32 v117, 0xffff0000, v82
    v_lshlrev_b32 v118, 16, v83
    v_and_b32 v119, 0xffff0000, v83
    v_readfirstlane_b32 s56, v112
    s_mov_b64 exec, -1
    v_mov_b32 v120, 0
    v_mov_b32 v121, 0
    s_mov_b32 exec_lo, -1
    s_mov_b32 exec_hi, 0x00ffffff
    s_mov_b32 s57, s56
    v_pk_add_f32 v[124:125], v[112:113], s[56:57] neg_lo:[0,1] neg_hi:[0,1]
    v_pk_add_f32 v[122:123], v[114:115], s[56:57] neg_lo:[0,1] neg_hi:[0,1]
    v_pk_mul_f32 v[126:127], v[124:125], v[124:125]
    v_pk_add_f32 v[124:125], v[124:125], v[122:123]
    v_pk_fma_f32 v[126:127], v[122:123], v[122:123], v[126:127]
    v_pk_add_f32 v[122:123], v[116:117], s[56:57] neg_lo:[0,1] neg_hi:[0,1]
    v_pk_add_f32 v[124:125], v[124:125], v[122:123]
    v_pk_fma_f32 v[126:127], v[122:123], v[122:123], v[126:127]
    v_pk_add_f32 v[122:123], v[118:119], s[56:57] neg_lo:[0,1] neg_hi:[0,1]
    v_pk_add_f32 v[124:125], v[124:125], v[122:123]
    v_pk_fma_f32 v[126:127], v[122:123], v[122:123], v[126:127]
    v_add_f32 v120, v124, v125
    v_add_f32 v121, v126, v127
    s_mov_b64 exec, -1
    s_nop 0
    v_add_f32_dpp v120, v120, v120 quad_perm:[1,0,3,2] row_mask:0xf bank_mask:0xf
    v_add_f32_dpp v121, v121, v121 quad_perm:[1,0,3,2] row_mask:0xf bank_mask:0xf
    s_nop 0
    v_add_f32_dpp v120, v120, v120 quad_perm:[2,3,0,1] row_mask:0xf bank_mask:0xf
    v_add_f32_dpp v121, v121, v121 quad_perm:[2,3,0,1] row_mask:0xf bank_mask:0xf
    s_nop 0
    v_add_f32_dpp v120, v120, v120 row_half_mirror row_mask:0xf bank_mask:0xf
    v_add_f32_dpp v121, v121, v121 row_half_mirror row_mask:0xf bank_mask:0xf
    s_nop 0
    v_add_f32_dpp v120, v120, v120 row_mirror row_mask:0xf bank_mask:0xf
    v_add_f32_dpp v121, v121, v121 row_mirror row_mask:0xf bank_mask:0xf
    v_mov_b32 v122, v120
    v_mov_b32 v123, v121
    s_nop 0
    v_permlane16_swap_b32 v122, v120
    v_permlane16_swap_b32 v123, v121
    v_add_f32 v120, v120, v122
    v_add_f32 v121, v121, v123
    v_mov_b32 v122, v120
    v_mov_b32 v123, v121
    s_nop 0
    v_permlane32_swap_b32 v122, v120
    v_permlane32_swap_b32 v123, v121
    v_add_f32 v120, v120, v122
    v_add_f32 v121, v121, v123
    v_mul_f32 v120, 0x3b124925, v120
    v_mul_f32 v121, 0x3b124925, v121
    v_fma_f32 v121, -v120, v120, v121
    v_max_f32 v121, 0, v121
    v_add_f32 v124, s56, v120
    v_cvt_pk_bf16_f32 v122, v124, v121
    v_lshlrev_b32 v124, 16, v122
    v_and_b32 v121, 0xffff0000, v122
    v_add_f32 v121, 0x3727c5ac, v121
    v_cvt_pk_bf16_f32 v121, v121, v121
    v_and_b32 v121, 0xffff0000, v121
    v_sqrt_f32 v121, v121
    v_pk_add_f32 v[112:113], v[112:113], v[124:125] op_sel_hi:[1,0] neg_lo:[0,1] neg_hi:[0,1]
    v_pk_add_f32 v[114:115], v[114:115], v[124:125] op_sel_hi:[1,0] neg_lo:[0,1] neg_hi:[0,1]
    v_cvt_pk_bf16_f32 v121, v121, v121
    v_and_b32 v121, 0xffff0000, v121
    v_rcp_f32 v126, v121
    v_pk_add_f32 v[116:117], v[116:117], v[124:125] op_sel_hi:[1,0] neg_lo:[0,1] neg_hi:[0,1]
    v_pk_add_f32 v[118:119], v[118:119], v[124:125] op_sel_hi:[1,0] neg_lo:[0,1] neg_hi:[0,1]
    v_cvt_pk_bf16_f32 v122, v112, v113
    v_lshlrev_b32 v112, 16, v122
    v_and_b32 v113, 0xffff0000, v122
    v_pk_mul_f32 v[112:113], v[112:113], v[126:127] op_sel_hi:[1,0]
    v_cvt_pk_bf16_f32 v122, v114, v115
    v_lshlrev_b32 v114, 16, v122
    v_and_b32 v115, 0xffff0000, v122
    v_pk_mul_f32 v[114:115], v[114:115], v[126:127] op_sel_hi:[1,0]
    v_cvt_pk_bf16_f32 v122, v116, v117
    v_lshlrev_b32 v116, 16, v122
    v_and_b32 v117, 0xffff0000, v122
    v_pk_mul_f32 v[116:117], v[116:117], v[126:127] op_sel_hi:[1,0]
    v_cvt_pk_bf16_f32 v122, v118, v119
    v_lshlrev_b32 v118, 16, v122
    v_and_b32 v119, 0xffff0000, v122
    v_pk_mul_f32 v[118:119], v[118:119], v[126:127] op_sel_hi:[1,0]
    v_cvt_pk_bf16_f32 v122, v112, v113
    v_lshlrev_b32 v112, 16, v122
    v_and_b32 v113, 0xffff0000, v122
    v_cvt_pk_bf16_f32 v122, v114, v115
    v_lshlrev_b32 v114, 16, v122
    v_and_b32 v115, 0xffff0000, v122
    v_cvt_pk_bf16_f32 v122, v116, v117
    v_lshlrev_b32 v116, 16, v122
    v_and_b32 v117, 0xffff0000, v122
    v_cvt_pk_bf16_f32 v122, v118, v119
    v_lshlrev_b32 v118, 16, v122
    v_and_b32 v119, 0xffff0000, v122
    s_mov_b32 exec_lo, -1
    s_mov_b32 exec_hi, 0x00ffffff
    s_mov_b64 exec, -1
L_r_noln:
    s_waitcnt vmcnt(0)
    s_mov_b64 exec, 1
    ds_add_u32 v9, v15 offset:8
    s_mov_b64 exec, -1
    s_cmp_eq_u32 s3, 2
    s_cbranch_scc1 L_a_fin
    s_cmp_eq_u32 s3, 1
    s_cbranch_scc1 L_a_gu
    s_cmp_ge_u32 s55, 4
    s_cbranch_scc1 L_r_nopc
    s_mov_b32 s62, 8000000
LW_24:
LWc_25:
    ds_read_b32 v10, v9 offset:8
    s_sub_u32 s62, s62, 1
    s_cselect_b32 s61, 0, 8
    s_waitcnt lgkmcnt(0)
    v_readfirstlane_b32 s63, v10
    s_nop 0
    s_cmp_lt_u32 s63, s61
    s_cbranch_scc1 LW_24
    ds_read_b64_tr_b16 v[16:17], v7 offset:0
    ds_read_b64_tr_b16 v[18:19], v7 offset:512
    ds_read_b64_tr_b16 v[20:21], v7 offset:4096
    ds_read_b64_tr_b16 v[22:23], v7 offset:4608
    ds_read_b64_tr_b16 v[24:25], v7 offset:8192
    ds_read_b64_tr_b16 v[26:27], v7 offset:8704
    ds_read_b64_tr_b16 v[28:29], v7 offset:12288
    ds_read_b64_tr_b16 v[30:31], v7 offset:12800
    ds_read_b64_tr_b16 v[32:33], v7 offset:16384
    ds_read_b64_tr_b16 v[34:35], v7 offset:16896
    ds_read_b64_tr_b16 v[36:37], v7 offset:20480
    ds_read_b64_tr_b16 v[38:39], v7 offset:20992
    ds_read_b64_tr_b16 v[40:41], v7 offset:24576
    ds_read_b64_tr_b16 v[42:43], v7 offset:25088
    ds_read_b64_tr_b16 v[44:45], v7 offset:28672
    ds_read_b64_tr_b16 v[46:47], v7 offset:29184
    ds_read_b64_tr_b16 v[48:49], v7 offset:32768
    ds_read_b64_tr_b16 v[50:51], v7 offset:33280
    ds_read_b64_tr_b16 v[52:53], v7 offset:36864
    ds_read_b64_tr_b16 v[54:55], v7 offset:37376
    ds_read_b64_tr_b16 v[56:57], v7 offset:40960
    ds_read_b64_tr_b16 v[58:59], v7 offset:41472
    ds_read_b64_tr_b16 v[60:61], v7 offset:45056
    ds_read_b64_tr_b16 v[62:63], v7 offset:45568
    ds_read_b64_tr_b16 v[64:65], v7 offset:49152
    ds_read_b64_tr_b16 v[66:67], v7 offset:49664
    ds_read_b64_tr_b16 v[68:69], v7 offset:53248
    ds_read_b64_tr_b16 v[70:71], v7 offset:53760
    s_waitcnt lgkmcnt(0)
    s_mov_b64 exec, 1
    ds_add_u32 v9, v15 offset:12
    s_mov_b64 exec, -1
L_r_nopc:
    s_cmp_lg_u32 s3, 3
    s_cbranch_scc1 L_a_early
    s_cmp_eq_u32 s55, 7
    s_cbranch_scc1 L_a_g1done
    s_lshl_b32 s63, s55, 12
    s_and_b32 s53, s96, 15
    s_lshl_b32 s53, s53, 7
    s_add_u32 s63, s63, s53
    s_add_u32 s63, s63, 2162688
    s_add_u32 s60, s4, s63
    s_addc_u32 s61, s5, 0
    s_mov_b32 s62, 1000000
    s_branch SGc_27
SG_26:
    s_sleep 2
SGc_27:
    s_load_dwordx4 s[8:11], s[60:61], 0 glc
    s_load_dwordx4 s[12:15], s[60:61], 2048 glc
    s_sub_u32 s62, s62, 1
    s_cselect_b32 s63, 0, -1
    s_waitcnt lgkmcnt(0)
    s_xor_b32 s8, s9, s11
    s_xor_b32 s8, s8, s51
    s_xor_b32 s12, s13, s15
    s_xor_b32 s12, s12, s51
    s_or_b32 s8, s8, s12
    s_and_b32 s8, s8, s63
    s_cbranch_scc1 SG_26
    s_mov_b64 exec, 1
    ds_add_u32 v9, v15 offset:32
    s_mov_b64 exec, -1
L_a_g1done:
    s_mov_b32 s62, 8000000
    s_branch LWc_29
LW_28:
    s_sleep 1
LWc_29:
    ds_read_b32 v10, v9 offset:32
    s_sub_u32 s62, s62, 1
    s_cselect_b32 s61, 0, 7
    s_waitcnt lgkmcnt(0)
    v_readfirstlane_b32 s63, v10
    s_nop 0
    s_cmp_lt_u32 s63, s61
    s_cbranch_scc1 LW_28
    v_lshrrev_b32 v12, 3, v1
    v_lshlrev_b32 v12, 11, v12
    v_and_b32 v13, 7, v1
    v_lshl_add_u32 v12, v13, 5, v12
    s_lshl_b32 s58, s55, 8
    s_add_u32 s58, s58, 2162688
    s_add_u32 s59, s58, 14336
    s_mul_i32 s53, s55, 1056
    s_add_u32 s53, s53, 138240
    v_lshlrev_b32 v11, 4, v1
    v_add_u32 v11, s53, v11
    s_mov_b32 exec_lo, -1
    s_mov_b32 exec_hi, 0x00ffffff
    s_mov_b32 s62, 1000000
    s_branch Gc_31
G_30:
    s_sleep 1
Gc_31:
    buffer_load_dwordx4 v[80:83], v12, s[4:7], s58 offen offset:0 sc1
    buffer_load_dwordx4 v[84:87], v12, s[4:7], s58 offen offset:16 sc1
    buffer_load_dwordx4 v[88:91], v12, s[4:7], s59 offen offset:0 sc1
    buffer_load_dwordx4 v[92:95], v12, s[4:7], s59 offen offset:16 sc1
    s_sub_u32 s62, s62, 1
    s_cselect_b64 s[60:61], 0, -1
    s_waitcnt vmcnt(3)
    v_bitop3_b32 v14, v80, v82, s50 bitop3:0x96
    v_bitop3_b32 v3, v81, v83, s51 bitop3:0x96
    v_or_b32 v13, v14, v3
    s_waitcnt vmcnt(2)
    v_bitop3_b32 v14, v84, v86, s50 bitop3:0x96
    v_bitop3_b32 v3, v85, v87, s51 bitop3:0x96
    v_or3_b32 v13, v13, v14, v3
    s_waitcnt vmcnt(1)
    v_bitop3_b32 v14, v88, v90, s50 bitop3:0x96
    v_bitop3_b32 v3, v89, v91, s51 bitop3:0x96
    v_or3_b32 v13, v13, v14, v3
    s_waitcnt vmcnt(0)
    v_bitop3_b32 v14, v92, v94, s50 bitop3:0x96
    v_bitop3_b32 v3, v93, v95, s51 bitop3:0x96
    v_or3_b32 v13, v13, v14, v3
    v_cmp_ne_u32 vcc, 0, v13
    s_and_b64 vcc, vcc, s[60:61]
    s_cbranch_scc1 G_30
    v_lshlrev_b32 v104, 16, v88
    v_and_b32 v105, 0xffff0000, v88
    v_lshlrev_b32 v106, 16, v89
    v_and_b32 v107, 0xffff0000, v89
    v_lshlrev_b32 v108, 16, v92
    v_and_b32 v109, 0xffff0000, v92
    v_lshlrev_b32 v110, 16, v93
    v_and_b32 v111, 0xffff0000, v93
    v_pk_add_f32 v[104:105], v[104:105], 1.0 op_sel_hi:[1,0]
    v_pk_add_f32 v[106:107], v[106:107], 1.0 op_sel_hi:[1,0]
    v_pk_add_f32 v[108:109], v[108:109], 1.0 op_sel_hi:[1,0]
    v_pk_add_f32 v[110:111], v[110:111], 1.0 op_sel_hi:[1,0]
    v_cvt_pk_bf16_f32 v13, v104, v105
    v_lshlrev_b32 v104, 16, v13
    v_and_b32 v105, 0xffff0000, v13
    v_cvt_pk_bf16_f32 v13, v106, v107
    v_lshlrev_b32 v106, 16, v13
    v_and_b32 v107, 0xffff0000, v13
    v_cvt_pk_bf16_f32 v13, v108, v109
    v_lshlrev_b32 v108, 16, v13
    v_and_b32 v109, 0xffff0000, v13
    v_cvt_pk_bf16_f32 v13, v110, v111
    v_lshlrev_b32 v110, 16, v13
    v_and_b32 v111, 0xffff0000, v13
    v_lshlrev_b32 v96, 16, v80
    v_and_b32 v97, 0xffff0000, v80
    v_lshlrev_b32 v98, 16, v81
    v_and_b32 v99, 0xffff0000, v81
    v_lshlrev_b32 v100, 16, v84
    v_and_b32 v101, 0xffff0000, v84
    v_lshlrev_b32 v102, 16, v85
    v_and_b32 v103, 0xffff0000, v85
    v_pk_mul_f32 v[112:113], v[112:113], v[104:105]
    v_cvt_pk_bf16_f32 v13, v112, v113
    v_lshlrev_b32 v112, 16, v13
    v_and_b32 v113, 0xffff0000, v13
    v_pk_add_f32 v[112:113], v[112:113], v[96:97]
    v_cvt_pk_bf16_f32 v80, v112, v113
    v_pk_mul_f32 v[114:115], v[114:115], v[106:107]
    v_cvt_pk_bf16_f32 v13, v114, v115
    v_lshlrev_b32 v114, 16, v13
    v_and_b32 v115, 0xffff0000, v13
    v_pk_add_f32 v[114:115], v[114:115], v[98:99]
    v_cvt_pk_bf16_f32 v81, v114, v115
    v_pk_mul_f32 v[116:117], v[116:117], v[108:109]
    v_cvt_pk_bf16_f32 v13, v116, v117
    v_lshlrev_b32 v116, 16, v13
    v_and_b32 v117, 0xffff0000, v13
    v_pk_add_f32 v[116:117], v[116:117], v[100:101]
    v_cvt_pk_bf16_f32 v82, v116, v117
    v_pk_mul_f32 v[118:119], v[118:119], v[110:111]
    v_cvt_pk_bf16_f32 v13, v118, v119
    v_lshlrev_b32 v118, 16, v13
    v_and_b32 v119, 0xffff0000, v13
    v_pk_add_f32 v[118:119], v[118:119], v[102:103]
    v_cvt_pk_bf16_f32 v83, v118, v119
    ds_write_b128 v11, v[80:83]
    s_mov_b64 exec, 1
    ds_add_u32 v9, v15 offset:0
    s_mov_b64 exec, -1
L_a_early:
    s_cmp_ge_u32 s55, 4
    s_cbranch_scc1 L_v_main
    s_mov_b32 s62, 8000000
LW_32:
LWc_33:
    ds_read_b32 v10, v9 offset:0
    s_sub_u32 s62, s62, 1
    s_cselect_b32 s61, 0, 8
    s_waitcnt lgkmcnt(0)
    v_readfirstlane_b32 s63, v10
    s_nop 0
    s_cmp_lt_u32 s63, s61
    s_cbranch_scc1 LW_32
    ds_read_b128 v[72:75], v5 offset:0
    ds_read_b128 v[76:79], v5 offset:64
    ds_read_b128 v[80:83], v5 offset:128
    ds_read_b128 v[84:87], v5 offset:192
    ds_read_b128 v[88:91], v5 offset:256
    ds_read_b128 v[92:95], v5 offset:320
    ds_read_b128 v[96:99], v5 offset:384
    ds_read_b128 v[100:103], v5 offset:448
    ds_read_b128 v[104:107], v5 offset:512
    ds_read_b128 v[108:111], v5 offset:576
    ds_read_b128 v[112:115], v5 offset:640
    ds_read_b128 v[116:119], v5 offset:704
    s_waitcnt lgkmcnt(11)
    v_mfma_f32_16x16x32_bf16 v[120:123], v[16:19], v[72:75], 0
    ds_read_b128 v[72:75], v5 offset:768
    s_waitcnt lgkmcnt(11)
    v_mfma_f32_16x16x32_bf16 v[120:123], v[20:23], v[76:79], v[120:123]
    ds_read_b128 v[76:79], v5 offset:832
    s_waitcnt lgkmcnt(11)
    v_mfma_f32_16x16x32_bf16 v[120:123], v[24:27], v[80:83], v[120:123]
    s_waitcnt lgkmcnt(10)
    v_mfma_f32_16x16x32_bf16 v[120:123], v[28:31], v[84:87], v[120:123]
    s_waitcnt lgkmcnt(9)
    v_mfma_f32_16x16x32_bf16 v[120:123], v[32:35], v[88:91], v[120:123]
    s_waitcnt lgkmcnt(8)
    v_mfma_f32_16x16x32_bf16 v[120:123], v[36:39], v[92:95], v[120:123]
    s_waitcnt lgkmcnt(7)
    v_mfma_f32_16x16x32_bf16 v[120:123], v[40:43], v[96:99], v[120:123]
    s_waitcnt lgkmcnt(6)
    v_mfma_f32_16x16x32_bf16 v[120:123], v[44:47], v[100:103], v[120:123]
    s_waitcnt lgkmcnt(5)
    v_mfma_f32_16x16x32_bf16 v[120:123], v[48:51], v[104:107], v[120:123]
    s_waitcnt lgkmcnt(4)
    v_mfma_f32_16x16x32_bf16 v[120:123], v[52:55], v[108:111], v[120:123]
    s_waitcnt lgkmcnt(3)
    v_mfma_f32_16x16x32_bf16 v[120:123], v[56:59], v[112:115], v[120:123]
    s_waitcnt lgkmcnt(2)
    v_mfma_f32_16x16x32_bf16 v[120:123], v[60:63], v[116:119], v[120:123]
    s_waitcnt lgkmcnt(1)
    v_mfma_f32_16x16x32_bf16 v[120:123], v[64:67], v[72:75], v[120:123]
    s_waitcnt lgkmcnt(0)
    v_mfma_f32_16x16x32_bf16 v[120:123], v[68:71], v[76:79], v[120:123]
    s_mov_b32 exec_lo, 0xff00ff
    s_mov_b32 exec_hi, 0xff00ff
    s_nop 5
    v_cvt_pk_bf16_f32 v80, v120, v121
    v_cvt_pk_bf16_f32 v81, v122, v123
    v_xor_b32 v82, s50, v80
    v_xor_b32 v83, s51, v81
    buffer_store_dwordx4 v[80:83], v8, s[4:7], s99 offen sc1
    s_mov_b64 exec, 1
    ds_add_u32 v9, v15 offset:4
    s_mov_b64 exec, -1
    s_branch L_v_main
L_a_gu:
    s_cmp_ge_u32 s55, 4
    s_cbranch_scc1 L_fin
    v_bfe_u32 v10, v1, 2, 2
    v_lshl_add_u32 v10, v6, 3, v10
    v_lshlrev_b32 v7, 6, v10
    v_and_b32 v10, 1, v1
    v_lshl_add_u32 v7, v10, 3, v7
    v_bfe_u32 v10, v1, 1, 1
    v_mul_u32_u24 v10, 28672, v10
    v_add_u32 v7, v7, v10
    s_lshl_b32 s53, s55, 4
    s_add_u32 s53, s53, 65536
    v_add_u32 v7, s53, v7
    s_mov_b32 s62, 8000000
LW_34:
LWc_35:
    ds_read_b32 v10, v9 offset:8
    s_sub_u32 s62, s62, 1
    s_cselect_b32 s61, 0, 8
    s_waitcnt lgkmcnt(0)
    v_readfirstlane_b32 s63, v10
    s_nop 0
    s_cmp_lt_u32 s63, s61
    s_cbranch_scc1 LW_34
    ds_read_b64_tr_b16 v[16:17], v7 offset:0
    ds_read_b64_tr_b16 v[18:19], v7 offset:256
    ds_read_b64_tr_b16 v[20:21], v7 offset:2048
    ds_read_b64_tr_b16 v[22:23], v7 offset:2304
    ds_read_b64_tr_b16 v[24:25], v7 offset:4096
    ds_read_b64_tr_b16 v[26:27], v7 offset:4352
    ds_read_b64_tr_b16 v[28:29], v7 offset:6144
    ds_read_b64_tr_b16 v[30:31], v7 offset:6400
    ds_read_b64_tr_b16 v[32:33], v7 offset:8192
    ds_read_b64_tr_b16 v[34:35], v7 offset:8448
    ds_read_b64_tr_b16 v[36:37], v7 offset:10240
    ds_read_b64_tr_b16 v[38:39], v7 offset:10496
    ds_read_b64_tr_b16 v[40:41], v7 offset:12288
    ds_read_b64_tr_b16 v[42:43], v7 offset:12544
    ds_read_b64_tr_b16 v[44:45], v7 offset:14336
    ds_read_b64_tr_b16 v[46:47], v7 offset:14592
    ds_read_b64_tr_b16 v[48:49], v7 offset:16384
    ds_read_b64_tr_b16 v[50:51], v7 offset:16640
    ds_read_b64_tr_b16 v[52:53], v7 offset:18432
    ds_read_b64_tr_b16 v[54:55], v7 offset:18688
    ds_read_b64_tr_b16 v[56:57], v7 offset:20480
    ds_read_b64_tr_b16 v[58:59], v7 offset:20736
    ds_read_b64_tr_b16 v[60:61], v7 offset:22528
    ds_read_b64_tr_b16 v[62:63], v7 offset:22784
    ds_read_b64_tr_b16 v[64:65], v7 offset:24576
    ds_read_b64_tr_b16 v[66:67], v7 offset:24832
    ds_read_b64_tr_b16 v[68:69], v7 offset:26624
    ds_read_b64_tr_b16 v[70:71], v7 offset:26880
    s_waitcnt lgkmcnt(0)
    s_setprio 3
    s_barrier
    ds_read_b128 v[72:75], v5 offset:0
    ds_read_b128 v[76:79], v5 offset:64
    ds_read_b128 v[80:83], v5 offset:128
    ds_read_b128 v[84:87], v5 offset:192
    ds_read_b128 v[88:91], v5 offset:256
    ds_read_b128 v[92:95], v5 offset:320
    ds_read_b128 v[96:99], v5 offset:384
    ds_read_b128 v[100:103], v5 offset:448
    ds_read_b128 v[104:107], v5 offset:512
    ds_read_b128 v[108:111], v5 offset:576
    ds_read_b128 v[112:115], v5 offset:640
    ds_read_b128 v[116:119], v5 offset:704
    s_waitcnt lgkmcnt(11)
    v_mfma_f32_16x16x32_bf16 v[120:123], v[16:19], v[72:75], 0
    ds_read_b128 v[72:75], v5 offset:768
    s_waitcnt lgkmcnt(11)
    v_mfma_f32_16x16x32_bf16 v[120:123], v[20:23], v[76:79], v[120:123]
    ds_read_b128 v[76:79], v5 offset:832
    s_waitcnt lgkmcnt(11)
    v_mfma_f32_16x16x32_bf16 v[120:123], v[24:27], v[80:83], v[120:123]
    s_waitcnt lgkmcnt(10)
    v_mfma_f32_16x16x32_bf16 v[120:123], v[28:31], v[84:87], v[120:123]
    s_waitcnt lgkmcnt(9)
    v_mfma_f32_16x16x32_bf16 v[120:123], v[32:35], v[88:91], v[120:123]
    s_waitcnt lgkmcnt(8)
    v_mfma_f32_16x16x32_bf16 v[120:123], v[36:39], v[92:95], v[120:123]
    s_waitcnt lgkmcnt(7)
    v_mfma_f32_16x16x32_bf16 v[120:123], v[40:43], v[96:99], v[120:123]
    s_waitcnt lgkmcnt(6)
    v_mfma_f32_16x16x32_bf16 v[120:123], v[44:47], v[100:103], v[120:123]
    s_waitcnt lgkmcnt(5)
    v_mfma_f32_16x16x32_bf16 v[120:123], v[48:51], v[104:107], v[120:123]
    s_waitcnt lgkmcnt(4)
    v_mfma_f32_16x16x32_bf16 v[120:123], v[52:55], v[108:111], v[120:123]
    s_waitcnt lgkmcnt(3)
    v_mfma_f32_16x16x32_bf16 v[120:123], v[56:59], v[112:115], v[120:123]
    s_waitcnt lgkmcnt(2)
    v_mfma_f32_16x16x32_bf16 v[120:123], v[60:63], v[116:119], v[120:123]
    s_waitcnt lgkmcnt(1)
    v_mfma_f32_16x16x32_bf16 v[120:123], v[64:67], v[72:75], v[120:123]
    s_waitcnt lgkmcnt(0)
    v_mfma_f32_16x16x32_bf16 v[120:123], v[68:71], v[76:79], v[120:123]
    s_nop 7
    v_cvt_pk_bf16_f32 v3, v120, v121
    v_lshlrev_b32 v120, 16, v3
    v_and_b32 v121, 0xffff0000, v3
    v_cvt_pk_bf16_f32 v4, v122, v123
    v_lshlrev_b32 v122, 16, v4
    v_and_b32 v123, 0xffff0000, v4
    v_mov_b32 v124, v120
    v_mov_b32 v125, v121
    v_mov_b32 v126, v122
    v_mov_b32 v127, v123
    v_permlane32_swap_b32 v120, v124
    v_permlane32_swap_b32 v121, v125
    v_permlane32_swap_b32 v122, v126
    v_permlane32_swap_b32 v123, v127
    v_mul_f32 v16, 0xbfb8aa3b, v120
    v_mul_f32 v19, 0xbfb8aa3b, v121
    v_mul_f32 v22, 0xbfb8aa3b, v122
    v_mul_f32 v25, 0xbfb8aa3b, v123
    v_exp_f32 v16, v16
    v_exp_f32 v19, v19
    v_exp_f32 v22, v22
    v_exp_f32 v25, v25
    v_add_f32 v16, 1.0, v16
    v_add_f32 v19, 1.0, v19
    v_add_f32 v22, 1.0, v22
    v_add_f32 v25, 1.0, v25
    v_min_f32 v16, 0x7e000000, v16
    v_min_f32 v19, 0x7e000000, v19
    v_min_f32 v22, 0x7e000000, v22
    v_min_f32 v25, 0x7e000000, v25
    v_rcp_f32 v17, v16
    v_rcp_f32 v20, v19
    v_rcp_f32 v23, v22
    v_rcp_f32 v26, v25
    v_mul_f32 v18, v120, v17
    v_mul_f32 v21, v121, v20
    v_mul_f32 v24, v122, v23
    v_mul_f32 v27, v123, v26
    v_fma_f32 v16, -v18, v16, v120
    v_fma_f32 v19, -v21, v19, v121
    v_fma_f32 v22, -v24, v22, v122
    v_fma_f32 v25, -v27, v25, v123
    v_fma_f32 v120, v16, v17, v18
    v_fma_f32 v121, v19, v20, v21
    v_fma_f32 v122, v22, v23, v24
    v_fma_f32 v123, v25, v26, v27
    v_cvt_pk_bf16_f32 v3, v120, v121
    v_lshlrev_b32 v120, 16, v3
    v_and_b32 v121, 0xffff0000, v3
    v_cvt_pk_bf16_f32 v4, v122, v123
    v_lshlrev_b32 v122, 16, v4
    v_and_b32 v123, 0xffff0000, v4
    v_pk_mul_f32 v[120:121], v[120:121], v[124:125]
    v_pk_mul_f32 v[122:123], v[122:123], v[126:127]
    v_cvt_pk_bf16_f32 v16, v120, v121
    v_cvt_pk_bf16_f32 v17, v122, v123
    s_mov_b64 exec, 0x00ff00ff
    v_xor_b32 v18, s50, v16
    v_xor_b32 v19, s51, v17
    buffer_store_dwordx4 v[16:19], v8, s[4:7], s99 offen sc1
    s_add_u32 s53, s96, s55
    s_cmp_lg_u32 s53, 0
    s_cbranch_scc1 L_fin
    s_mov_b64 exec, 1
    v_mov_b32 v12, s50
    v_mov_b32 v13, 0
    buffer_store_dword v12, v13, s[4:7], 0 offen sc1
    s_branch L_fin
L_r_late:
    s_cmp_eq_u32 s3, 2
    s_cbranch_scc1 L_r_fin
    s_cmp_lt_u32 s55, 4
    s_cselect_b32 s8, s28, s30
    s_cselect_b32 s9, s29, s31
    s_mov_b32 s10, 1605632
    s_mov_b32 s11, 0x20000
    s_mov_b32 s60, 94208
    s_cselect_b32 s60, 65536, s60
    s_and_b32 s53, s55, 3
    s_lshl_b32 s54, s53, 10
    s_add_u32 s60, s60, s54
    v_lshrrev_b32 v2, 2, v1
    v_mul_u32_u24 v2, 3584, v2
    v_and_b32 v3, 3, v1
    v_lshl_add_u32 v2, v3, 4, v2
    s_mul_i32 s58, s53, 57344
    s_lshl_b32 s54, s96, 6
    s_add_u32 s58, s58, s54
    s_mov_b32 s59, 229376
    s_movk_i32 s57, 0x1000
    s_branch L_r_go2
L_r_fin:
    s_mov_b32 s8, s32
    s_mov_b32 s9, s33
    s_mov_b32 s10, 1605632
    s_mov_b32 s11, 0x20000
    v_bfe_u32 v2, v1, 3, 2
    v_lshlrev_b32 v2, 3, v2
    v_bfe_u32 v3, v1, 1, 2
    v_add_u32 v2, v2, v3
    v_lshrrev_b32 v3, 5, v1
    v_lshl_add_u32 v2, v3, 2, v2
    v_mul_u32_u24 v2, 896, v2
    v_and_b32 v3, 1, v1
    v_lshl_add_u32 v2, v3, 4, v2
    s_mul_i32 s58, s55, 28672
    s_lshl_b32 s53, s96, 5
    s_add_u32 s58, s58, s53
    s_mov_b32 s59, 229376
    s_branch L_r_go1
L_a_fin:
    s_lshl_b32 s53, s55, 10
    s_add_u32 s53, s53, 65536
    v_lshlrev_b32 v7, 3, v1
    v_add_u32 v7, s53, v7
    ds_read_b64_tr_b16 v[80:81], v7 offset:0
    ds_read_b64_tr_b16 v[82:83], v7 offset:512
    ds_read_b64_tr_b16 v[84:85], v7 offset:8192
    ds_read_b64_tr_b16 v[86:87], v7 offset:8704
    ds_read_b64_tr_b16 v[88:89], v7 offset:16384
    ds_read_b64_tr_b16 v[90:91], v7 offset:16896
    ds_read_b64_tr_b16 v[92:93], v7 offset:24576
    ds_read_b64_tr_b16 v[94:95], v7 offset:25088
    ds_read_b64_tr_b16 v[96:97], v7 offset:32768
    ds_read_b64_tr_b16 v[98:99], v7 offset:33280
    ds_read_b64_tr_b16 v[100:101], v7 offset:40960
    ds_read_b64_tr_b16 v[102:103], v7 offset:41472
    ds_read_b64_tr_b16 v[104:105], v7 offset:49152
    ds_read_b64_tr_b16 v[106:107], v7 offset:49664
    v_and_b32 v14, 7, v1
    v_lshlrev_b32 v8, 6, v14
    v_lshl_add_u32 v8, v6, 4, v8
    s_lshl_b32 s53, s55, 9
    s_add_u32 s53, s53, 150784
    v_add_u32 v8, s53, v8
    s_mov_b32 s8, s38
    s_mov_b32 s9, s39
    s_mov_b32 s10, 7168
    s_mov_b32 s11, 0x20000
    s_cmp_lg_u32 s55, 7
    s_cbranch_scc1 L_a_fin2
    v_lshrrev_b32 v12, 3, v1
    v_bfe_u32 v13, v1, 1, 2
    v_lshlrev_b32 v13, 4, v13
    v_mul_u32_u24 v10, 1792, v12
    v_add_u32 v10, v10, v13
    v_and_b32 v14, 1, v1
    v_cmp_ne_u32 s[98:99], 0, v14
    s_lshl_b32 s58, s96, 6
    s_add_u32 s58, s58, 20480
    s_mov_b32 s62, 1000000
    s_branch Gc_37
G_36:
    s_sleep 2
Gc_37:
    buffer_load_dwordx4 v[76:79], v10, s[4:7], s58 offen offset:0 sc1
    s_sub_u32 s62, s62, 1
    s_cselect_b64 s[60:61], 0, -1
    s_waitcnt vmcnt(0)
    v_bitop3_b32 v14, v76, v78, s50 bitop3:0x96
    v_bitop3_b32 v3, v77, v79, s51 bitop3:0x96
    v_or_b32 v48, v14, v3
    v_cmp_ne_u32 vcc, 0, v48
    s_and_b64 vcc, vcc, s[60:61]
    s_cbranch_scc1 G_36
    s_mov_b64 exec, 1
    ds_add_u32 v9, v15 offset:28
    s_mov_b64 exec, -1
    v_cndmask_b32 v76, v76, v77, s[98:99]
    v_lshlrev_b32 v58, 16, v76
    v_and_b32 v59, 0xffff0000, v76
L_a_fin2:
    v_lshlrev_b32 v12, 4, v1
    s_lshl_b32 s58, s55, 10
    s_add_u32 s58, s58, 2097152
    v_add_u32 v45, 8192, v12
    v_add_u32 v46, 16384, v12
    v_add_u32 v47, 24576, v12
    v_add_u32 v48, 32768, v12
    v_add_u32 v49, 40960, v12
    v_add_u32 v50, 49152, v12
    s_setprio 3
    s_mov_b32 s62, 8000000
    s_branch LWc_39
LW_38:
    s_sleep 2
LWc_39:
    ds_read_b32 v10, v9 offset:28
    s_sub_u32 s62, s62, 1
    s_cselect_b32 s61, 0, 1
    s_waitcnt lgkmcnt(0)
    v_readfirstlane_b32 s63, v10
    s_nop 0
    s_cmp_lt_u32 s63, s61
    s_cbranch_scc1 LW_38
    s_mov_b32 s62, 1000000
G_40:
Gc_41:
    buffer_load_dwordx4 v[16:19], v12, s[4:7], s58 offen offset:0 sc1
    buffer_load_dwordx4 v[20:23], v45, s[4:7], s58 offen offset:0 sc1
    buffer_load_dwordx4 v[24:27], v46, s[4:7], s58 offen offset:0 sc1
    buffer_load_dwordx4 v[28:31], v47, s[4:7], s58 offen offset:0 sc1
    buffer_load_dwordx4 v[32:35], v48, s[4:7], s58 offen offset:0 sc1
    buffer_load_dwordx4 v[36:39], v49, s[4:7], s58 offen offset:0 sc1
    buffer_load_dwordx4 v[40:43], v50, s[4:7], s58 offen offset:0 sc1
    s_sub_u32 s62, s62, 1
    s_cselect_b64 s[60:61], 0, -1
    s_waitcnt vmcnt(6)
    v_bitop3_b32 v14, v16, v18, s50 bitop3:0x96
    v_bitop3_b32 v3, v17, v19, s51 bitop3:0x96
    v_or_b32 v13, v14, v3
    s_waitcnt vmcnt(5)
    v_bitop3_b32 v14, v20, v22, s50 bitop3:0x96
    v_bitop3_b32 v3, v21, v23, s51 bitop3:0x96
    v_or3_b32 v13, v13, v14, v3
    s_waitcnt vmcnt(4)
    v_bitop3_b32 v14, v24, v26, s50 bitop3:0x96
    v_bitop3_b32 v3, v25, v27, s51 bitop3:0x96
    v_or3_b32 v13, v13, v14, v3
    s_waitcnt vmcnt(3)
    v_bitop3_b32 v14, v28, v30, s50 bitop3:0x96
    v_bitop3_b32 v3, v29, v31, s51 bitop3:0x96
    v_or3_b32 v13, v13, v14, v3
    s_waitcnt vmcnt(2)
    v_bitop3_b32 v14, v32, v34, s50 bitop3:0x96
    v_bitop3_b32 v3, v33, v35, s51 bitop3:0x96
    v_or3_b32 v13, v13, v14, v3
    s_waitcnt vmcnt(1)
    v_bitop3_b32 v14, v36, v38, s50 bitop3:0x96
    v_bitop3_b32 v3, v37, v39, s51 bitop3:0x96
    v_or3_b32 v13, v13, v14, v3
    s_waitcnt vmcnt(0)
    v_bitop3_b32 v14, v40, v42, s50 bitop3:0x96
    v_bitop3_b32 v3, v41, v43, s51 bitop3:0x96
    v_or3_b32 v13, v13, v14, v3
    v_cmp_ne_u32 vcc, 0, v13
    s_and_b64 vcc, vcc, s[60:61]
    s_cbranch_scc1 G_40
    v_mov_b32_dpp v18, v16 row_ror:8 row_mask:0xf bank_mask:0xf
    v_mov_b32_dpp v19, v17 row_ror:8 row_mask:0xf bank_mask:0xf
    v_mov_b32_dpp v22, v20 row_ror:8 row_mask:0xf bank_mask:0xf
    v_mov_b32_dpp v23, v21 row_ror:8 row_mask:0xf bank_mask:0xf
    v_mfma_f32_16x16x32_bf16 v[124:127], v[80:83], v[16:19], 0
    v_mov_b32_dpp v26, v24 row_ror:8 row_mask:0xf bank_mask:0xf
    v_mov_b32_dpp v27, v25 row_ror:8 row_mask:0xf bank_mask:0xf
    v_mfma_f32_16x16x32_bf16 v[124:127], v[84:87], v[20:23], v[124:127]
    v_mov_b32_dpp v30, v28 row_ror:8 row_mask:0xf bank_mask:0xf
    v_mov_b32_dpp v31, v29 row_ror:8 row_mask:0xf bank_mask:0xf
    v_mfma_f32_16x16x32_bf16 v[124:127], v[88:91], v[24:27], v[124:127]
    v_mov_b32_dpp v34, v32 row_ror:8 row_mask:0xf bank_mask:0xf
    v_mov_b32_dpp v35, v33 row_ror:8 row_mask:0xf bank_mask:0xf
    v_mfma_f32_16x16x32_bf16 v[124:127], v[92:95], v[28:31], v[124:127]
    v_mov_b32_dpp v38, v36 row_ror:8 row_mask:0xf bank_mask:0xf
    v_mov_b32_dpp v39, v37 row_ror:8 row_mask:0xf bank_mask:0xf
    v_mfma_f32_16x16x32_bf16 v[124:127], v[96:99], v[32:35], v[124:127]
    v_mov_b32_dpp v42, v40 row_ror:8 row_mask:0xf bank_mask:0xf
    v_mov_b32_dpp v43, v41 row_ror:8 row_mask:0xf bank_mask:0xf
    v_mfma_f32_16x16x32_bf16 v[124:127], v[100:103], v[36:39], v[124:127]
    s_nop 0
    v_mfma_f32_16x16x32_bf16 v[124:127], v[104:107], v[40:43], v[124:127]
    s_mov_b32 exec_lo, 0xff00ff
    s_mov_b32 exec_hi, 0xff00ff
    s_cmp_lg_u32 s55, 7
    s_nop 4
    ds_write_b128 v8, v[124:127]
    s_mov_b64 exec, -1
    s_waitcnt lgkmcnt(0)
    s_barrier
    s_cbranch_scc1 L_fin
    ds_read_b64 v[16:17], v60 offset:0
    ds_read_b64 v[18:19], v60 offset:512
    ds_read_b64 v[20:21], v60 offset:1024
    ds_read_b64 v[22:23], v60 offset:1536
    ds_read_b64 v[24:25], v60 offset:2048
    ds_read_b64 v[26:27], v60 offset:2560
    ds_read_b64 v[28:29], v60 offset:3072
    ds_read_b64 v[30:31], v60 offset:3584
    s_waitcnt lgkmcnt(0)
    v_pk_add_f32 v[16:17], v[16:17], v[24:25]
    v_pk_add_f32 v[18:19], v[18:19], v[26:27]
    v_pk_add_f32 v[20:21], v[20:21], v[28:29]
    v_pk_add_f32 v[22:23], v[22:23], v[30:31]
    v_pk_add_f32 v[16:17], v[16:17], v[20:21]
    v_pk_add_f32 v[18:19], v[18:19], v[22:23]
    v_pk_add_f32 v[16:17], v[16:17], v[18:19]
    v_cvt_pk_bf16_f32 v3, v16, v17
    v_lshlrev_b32 v16, 16, v3
    v_and_b32 v17, 0xffff0000, v3
    v_pk_mul_f32 v[16:17], v[16:17], v[56:57]
    v_cvt_pk_bf16_f32 v3, v16, v17
    v_lshlrev_b32 v16, 16, v3
    v_and_b32 v17, 0xffff0000, v3
    v_pk_add_f32 v[16:17], v[16:17], v[58:59]
    v_cvt_pk_bf16_f32 v16, v16, v17
    buffer_store_dword v16, v61, s[8:11], s97 offen
    s_branch L_fin
L_v_main:
    s_setprio 2
    s_waitcnt lgkmcnt(0)
    s_add_u32 s50, s44, 1
    s_mul_i32 s51, s50, 0x9E3779B1
    s_or_b32 s51, s51, 0x80000001
    s_lshl_b32 s53, s55, 2
    v_add_u32 v126, s53, v9
    v_lshrrev_b32 v13, 3, v1
    v_and_b32 v4, 7, v1
    v_lshlrev_b32 v4, 4, v4
    v_bfe_u32 v14, v1, 4, 1
    v_lshlrev_b32 v14, 5, v14
    v_xor_b32 v4, v4, v14
    v_lshl_add_u32 v4, v13, 9, v4
    s_mov_b32 s12, s20
    s_mov_b32 s13, s21
    s_mov_b32 s14, 134217728
    s_mov_b32 s15, 0x20000
    s_lshl_b32 s54, s49, 21
    s_lshl_b32 s53, s47, 7
    s_add_u32 s54, s54, s53
    s_add_u32 s54, s54, 1572864
    s_mul_i32 s57, s49, 37
    s_add_u32 s57, s57, s55
    s_and_b32 s101, s57, 7
    s_bfe_u32 s57, s57, 0x40003
    s_lshl_b32 s53, s101, 12
    s_add_u32 s54, s54, s53
    s_mov_b32 s56, 0
    s_mov_b32 s98, s97
    v_bfe_u32 v13, v1, 2, 2
    v_and_b32 v14, 3, v1
    v_lshlrev_b32 v5, 10, v6
    v_lshl_add_u32 v5, v13, 7, v5
    v_lshl_add_u32 v5, v14, 3, v5
    v_bfe_u32 v14, v1, 3, 2
    v_lshl_add_u32 v5, v14, 5, v5
    v_xor_b32 v2, 32, v5
    v_xor_b32 v7, 64, v5
    v_xor_b32 v8, 0x60, v5
    v_add_u32 v5, s97, v5
    v_add_u32 v2, s97, v2
    v_add_u32 v7, s97, v7
    v_add_u32 v8, s97, v8
    v_add_u32 v11, s57, v6
    v_and_b32 v12, 1, v1
    v_lshlrev_b32 v12, 11, v12
    s_lshl_b32 s53, s101, 4
    s_add_u32 s53, s53, 146688
    v_add_u32 v12, s53, v12
    v_add_u32 v13, 0, v11
    v_and_b32 v13, 15, v13
    v_lshl_add_u32 v112, v13, 7, v12
    v_add_u32 v13, 4, v11
    v_and_b32 v13, 15, v13
    v_lshl_add_u32 v113, v13, 7, v12
    v_add_u32 v13, 8, v11
    v_and_b32 v13, 15, v13
    v_lshl_add_u32 v114, v13, 7, v12
    v_add_u32 v13, 12, v11
    v_and_b32 v13, 15, v13
    v_lshl_add_u32 v115, v13, 7, v12
    v_lshlrev_b32 v10, 2, v1
    s_lshl_b32 s53, s55, 9
    s_add_u32 s53, s53, 155904
    v_add_u32 v10, s53, v10
    s_mov_b32 s8, s24
    s_mov_b32 s9, s25
    s_mov_b32 s10, 3670016
    s_mov_b32 s11, 0x20000
    v_lshrrev_b32 v12, 3, v1
    v_mul_u32_u24 v12, 896, v12
    v_and_b32 v14, 7, v1
    v_lshl_add_u32 v12, v14, 4, v12
    s_lshl_b32 s99, s46, 9
    s_lshl_b32 s59, s47, 6
    s_add_u32 s99, s99, s59
    s_mul_i32 s99, s99, 896
    s_lshl_b32 s59, s55, 7
    s_add_u32 s99, s99, s59
    s_lshl_b32 s53, s55, 10
    s_add_u32 s53, s53, 131072
    v_lshlrev_b32 v96, 4, v1
    v_add_u32 v96, s53, v96
    v_bfe_u32 v97, v1, 2, 2
    v_lshlrev_b32 v97, 7, v97
    v_lshl_add_u32 v97, v6, 5, v97
    v_and_b32 v13, 3, v1
    v_lshl_add_u32 v97, v13, 3, v97
    v_add_u32 v97, s53, v97
    s_cmp_eq_u32 s47, 3
    s_cselect_b64 vcc, -1, 0
    s_cmp_ge_u32 s3, 3
    s_cselect_b64 vcc, -1, vcc
    s_cbranch_scc1 L_v_burst
    s_cmp_eq_u32 s55, 7
    s_cbranch_scc1 L_v_w7
    buffer_load_dwordx4 v[16:19], v12, s[8:11], s99 offen
    s_add_u32 s99, s99, 7168
    buffer_load_dwordx4 v[20:23], v12, s[8:11], s99 offen
    s_add_u32 s99, s99, 7168
    s_waitcnt vmcnt(1)
    buffer_load_dwordx4 v[24:27], v12, s[8:11], s99 offen
    s_add_u32 s99, s99, 7168
    s_waitcnt vmcnt(1)
    buffer_load_dwordx4 v[28:31], v12, s[8:11], s99 offen
    s_add_u32 s99, s99, 7168
    s_waitcnt vmcnt(1)
    buffer_load_dwordx4 v[32:35], v12, s[8:11], s99 offen
    s_add_u32 s99, s99, 7168
    s_waitcnt vmcnt(1)
    buffer_load_dwordx4 v[36:39], v12, s[8:11], s99 offen
    s_add_u32 s99, s99, 7168
    s_waitcnt vmcnt(1)
    buffer_load_dwordx4 v[40:43], v12, s[8:11], s99 offen
    s_add_u32 s99, s99, 7168
    s_waitcnt vmcnt(1)
    buffer_load_dwordx4 v[44:47], v12, s[8:11], s99 offen
    s_add_u32 s99, s99, 179200
    s_waitcnt vmcnt(0)
    ds_write_b128 v96, v[16:19]
    ds_read_b64_tr_b16 v[16:17], v97
    ds_read_b64_tr_b16 v[18:19], v97 offset:512
    ds_write_b128 v96, v[20:23]
    ds_read_b64_tr_b16 v[20:21], v97
    ds_read_b64_tr_b16 v[22:23], v97 offset:512
    ds_write_b128 v96, v[24:27]
    ds_read_b64_tr_b16 v[24:25], v97
    ds_read_b64_tr_b16 v[26:27], v97 offset:512
    ds_write_b128 v96, v[28:31]
    ds_read_b64_tr_b16 v[28:29], v97
    ds_read_b64_tr_b16 v[30:31], v97 offset:512
    ds_write_b128 v96, v[32:35]
    ds_read_b64_tr_b16 v[32:33], v97
    ds_read_b64_tr_b16 v[34:35], v97 offset:512
    ds_write_b128 v96, v[36:39]
    ds_read_b64_tr_b16 v[36:37], v97
    ds_read_b64_tr_b16 v[38:39], v97 offset:512
    ds_write_b128 v96, v[40:43]
    ds_read_b64_tr_b16 v[40:41], v97
    ds_read_b64_tr_b16 v[42:43], v97 offset:512
    ds_write_b128 v96, v[44:47]
    ds_read_b64_tr_b16 v[44:45], v97
    ds_read_b64_tr_b16 v[46:47], v97 offset:512
    s_mov_b32 s62, 8000000
    s_branch LWc_43
LW_42:
    s_sleep 2
LWc_43:
    ds_read_b32 v13, v126 offset:64
    s_sub_u32 s62, s62, 1
    s_cselect_b32 s61, 0, 1
    s_waitcnt lgkmcnt(0)
    v_readfirstlane_b32 s63, v13
    s_nop 0
    s_cmp_lt_u32 s63, s61
    s_cbranch_scc1 LW_42
    s_mov_b32 s62, 8000000
    s_branch LWc_45
LW_44:
    s_sleep 1
LWc_45:
    ds_read_b32 v13, v9 offset:40
    s_sub_u32 s62, s62, 1
    s_cselect_b32 s61, 0, 8
    s_waitcnt lgkmcnt(0)
    v_readfirstlane_b32 s63, v13
    s_nop 0
    s_cmp_lt_u32 s63, s61
    s_cbranch_scc1 LW_44
    s_add_u32 s58, s56, s57
    s_and_b32 s58, s58, 15
    s_lshl_b32 s58, s58, 15
    s_add_u32 s58, s58, s54
    s_and_b32 s59, s56, 1
    s_lshl_b32 s59, s59, 6
    v_xor_b32 v3, s59, v4
    s_mov_b32 m0, s98
    s_add_u32 s98, s98, 1024
    s_add_u32 s56, s56, 1
    buffer_load_dwordx4 v3, s[12:15], s58 offen nt lds
    buffer_load_dwordx4 v[48:51], v12, s[8:11], s99 offen
    s_add_u32 s99, s99, 7168
    s_cbranch_vccnz WT_46
    s_waitcnt vmcnt(3)
WT_46:
    s_waitcnt vmcnt(8)
    s_add_u32 s58, s56, s57
    s_and_b32 s58, s58, 15
    s_lshl_b32 s58, s58, 15
    s_add_u32 s58, s58, s54
    s_and_b32 s59, s56, 1
    s_lshl_b32 s59, s59, 6
    v_xor_b32 v3, s59, v4
    s_mov_b32 m0, s98
    s_add_u32 s98, s98, 1024
    s_add_u32 s56, s56, 1
    buffer_load_dwordx4 v3, s[12:15], s58 offen nt lds
    buffer_load_dwordx4 v[52:55], v12, s[8:11], s99 offen
    s_add_u32 s99, s99, 7168
    s_cbranch_vccnz WT_47
    s_waitcnt vmcnt(3)
WT_47:
    s_waitcnt vmcnt(8)
    s_add_u32 s58, s56, s57
    s_and_b32 s58, s58, 15
    s_lshl_b32 s58, s58, 15
    s_add_u32 s58, s58, s54
    s_and_b32 s59, s56, 1
    s_lshl_b32 s59, s59, 6
    v_xor_b32 v3, s59, v4
    s_mov_b32 m0, s98
    s_add_u32 s98, s98, 1024
    s_add_u32 s56, s56, 1
    buffer_load_dwordx4 v3, s[12:15], s58 offen nt lds
    buffer_load_dwordx4 v[56:59], v12, s[8:11], s99 offen
    s_add_u32 s99, s99, 7168
    s_cbranch_vccnz WT_48
    s_waitcnt vmcnt(3)
WT_48:
    s_waitcnt vmcnt(8)
    s_add_u32 s58, s56, s57
    s_and_b32 s58, s58, 15
    s_lshl_b32 s58, s58, 15
    s_add_u32 s58, s58, s54
    s_and_b32 s59, s56, 1
    s_lshl_b32 s59, s59, 6
    v_xor_b32 v3, s59, v4
    s_mov_b32 m0, s98
    s_add_u32 s98, s98, 1024
    s_add_u32 s56, s56, 1
    buffer_load_dwordx4 v3, s[12:15], s58 offen nt lds
    buffer_load_dwordx4 v[60:63], v12, s[8:11], s99 offen
    s_add_u32 s99, s99, 7168
    s_cbranch_vccnz WT_49
    s_waitcnt vmcnt(3)
WT_49:
    s_waitcnt vmcnt(8)
    s_add_u32 s58, s56, s57
    s_and_b32 s58, s58, 15
    s_lshl_b32 s58, s58, 15
    s_add_u32 s58, s58, s54
    s_and_b32 s59, s56, 1
    s_lshl_b32 s59, s59, 6
    v_xor_b32 v3, s59, v4
    s_mov_b32 m0, s98
    s_add_u32 s98, s98, 1024
    s_add_u32 s56, s56, 1
    buffer_load_dwordx4 v3, s[12:15], s58 offen nt lds
    buffer_load_dwordx4 v[64:67], v12, s[8:11], s99 offen
    s_add_u32 s99, s99, 7168
    s_cbranch_vccnz WT_50
    s_waitcnt vmcnt(3)
WT_50:
    s_waitcnt vmcnt(8)
    s_add_u32 s58, s56, s57
    s_and_b32 s58, s58, 15
    s_lshl_b32 s58, s58, 15
    s_add_u32 s58, s58, s54
    s_and_b32 s59, s56, 1
    s_lshl_b32 s59, s59, 6
    v_xor_b32 v3, s59, v4
    s_mov_b32 m0, s98
    s_add_u32 s98, s98, 1024
    s_add_u32 s56, s56, 1
    buffer_load_dwordx4 v3, s[12:15], s58 offen nt lds
    buffer_load_dwordx4 v[68:71], v12, s[8:11], s99 offen
    s_add_u32 s99, s99, 7168
    s_cbranch_vccnz WT_51
    s_waitcnt vmcnt(3)
WT_51:
    s_waitcnt vmcnt(8)
    s_add_u32 s58, s56, s57
    s_and_b32 s58, s58, 15
    s_lshl_b32 s58, s58, 15
    s_add_u32 s58, s58, s54
    s_and_b32 s59, s56, 1
    s_lshl_b32 s59, s59, 6
    v_xor_b32 v3, s59, v4
    s_mov_b32 m0, s98
    s_add_u32 s98, s98, 1024
    s_add_u32 s56, s56, 1
    buffer_load_dwordx4 v3, s[12:15], s58 offen nt lds
    buffer_load_dwordx4 v[72:75], v12, s[8:11], s99 offen
    s_add_u32 s99, s99, 7168
    s_cbranch_vccnz WT_52
    s_waitcnt vmcnt(3)
WT_52:
    s_waitcnt vmcnt(8)
    s_add_u32 s58, s56, s57
    s_and_b32 s58, s58, 15
    s_lshl_b32 s58, s58, 15
    s_add_u32 s58, s58, s54
    s_and_b32 s59, s56, 1
    s_lshl_b32 s59, s59, 6
    v_xor_b32 v3, s59, v4
    s_mov_b32 m0, s98
    s_add_u32 s98, s98, 1024
    s_add_u32 s56, s56, 1
    buffer_load_dwordx4 v3, s[12:15], s58 offen nt lds
    buffer_load_dwordx4 v[76:79], v12, s[8:11], s99 offen
    s_branch L_v_mid
L_v_burst:
    s_mov_b32 s62, 8000000
    s_branch LWc_54
LW_53:
    s_sleep 1
LWc_54:
    ds_read_b32 v13, v9 offset:40
    s_sub_u32 s62, s62, 1
    s_cselect_b32 s61, 0, 8
    s_waitcnt lgkmcnt(0)
    v_readfirstlane_b32 s63, v13
    s_nop 0
    s_cmp_lt_u32 s63, s61
    s_cbranch_scc1 LW_53
    s_cmp_eq_u32 s55, 7
    s_cbranch_scc1 L_v_b7
    buffer_load_dwordx4 v[16:19], v12, s[8:11], s99 offen
    s_add_u32 s99, s99, 7168
    buffer_load_dwordx4 v[20:23], v12, s[8:11], s99 offen
    s_add_u32 s99, s99, 7168
    buffer_load_dwordx4 v[24:27], v12, s[8:11], s99 offen
    s_add_u32 s99, s99, 7168
    buffer_load_dwordx4 v[28:31], v12, s[8:11], s99 offen
    s_add_u32 s99, s99, 7168
    buffer_load_dwordx4 v[32:35], v12, s[8:11], s99 offen
    s_add_u32 s99, s99, 7168
    buffer_load_dwordx4 v[36:39], v12, s[8:11], s99 offen
    s_add_u32 s99, s99, 7168
    buffer_load_dwordx4 v[40:43], v12, s[8:11], s99 offen
    s_add_u32 s99, s99, 7168
    buffer_load_dwordx4 v[44:47], v12, s[8:11], s99 offen
    s_add_u32 s99, s99, 179200
    buffer_load_dwordx4 v[48:51], v12, s[8:11], s99 offen
    s_add_u32 s99, s99, 7168
    buffer_load_dwordx4 v[52:55], v12, s[8:11], s99 offen
    s_add_u32 s99, s99, 7168
    buffer_load_dwordx4 v[56:59], v12, s[8:11], s99 offen
    s_add_u32 s99, s99, 7168
    buffer_load_dwordx4 v[60:63], v12, s[8:11], s99 offen
    s_add_u32 s99, s99, 7168
    buffer_load_dwordx4 v[64:67], v12, s[8:11], s99 offen
    s_add_u32 s99, s99, 7168
    buffer_load_dwordx4 v[68:71], v12, s[8:11], s99 offen
    s_add_u32 s99, s99, 7168
    buffer_load_dwordx4 v[72:75], v12, s[8:11], s99 offen
    s_add_u32 s99, s99, 7168
    buffer_load_dwordx4 v[76:79], v12, s[8:11], s99 offen
L_v_bdone:
    s_mov_b64 exec, 1
    ds_add_u32 v9, v15 offset:44
    s_mov_b64 exec, -1
L_v_b7:
    s_mov_b32 s62, 8000000
    s_branch LWc_56
LW_55:
    s_sleep 2
LWc_56:
    ds_read_b32 v13, v126 offset:64
    s_sub_u32 s62, s62, 1
    s_cselect_b32 s61, 0, 1
    s_waitcnt lgkmcnt(0)
    v_readfirstlane_b32 s63, v13
    s_nop 0
    s_cmp_lt_u32 s63, s61
    s_cbranch_scc1 LW_55
    s_mov_b32 s62, 8000000
    s_branch LWc_58
LW_57:
    s_sleep 1
LWc_58:
    ds_read_b32 v13, v9 offset:44
    s_sub_u32 s62, s62, 1
    s_cselect_b32 s61, 0, 7
    s_waitcnt lgkmcnt(0)
    v_readfirstlane_b32 s63, v13
    s_nop 0
    s_cmp_lt_u32 s63, s61
    s_cbranch_scc1 LW_57
L_v_i00:
    s_add_u32 s58, s56, s57
    s_and_b32 s58, s58, 15
    s_lshl_b32 s58, s58, 15
    s_add_u32 s58, s58, s54
    s_and_b32 s59, s56, 1
    s_lshl_b32 s59, s59, 6
    v_xor_b32 v3, s59, v4
    s_mov_b32 m0, s98
    s_add_u32 s98, s98, 1024
    s_add_u32 s56, s56, 1
    buffer_load_dwordx4 v3, s[12:15], s58 offen nt lds
    s_cmp_lt_u32 s56, 2
    s_cbranch_scc1 L_v_i00
    s_branch L_v_i0
L_v_w7:
    s_mov_b32 s62, 8000000
    s_branch LWc_60
LW_59:
    s_sleep 2
LWc_60:
    ds_read_b32 v13, v126 offset:64
    s_sub_u32 s62, s62, 1
    s_cselect_b32 s61, 0, 1
    s_waitcnt lgkmcnt(0)
    v_readfirstlane_b32 s63, v13
    s_nop 0
    s_cmp_lt_u32 s63, s61
    s_cbranch_scc1 LW_59
    s_mov_b32 s62, 8000000
    s_branch LWc_62
LW_61:
    s_sleep 1
LWc_62:
    ds_read_b32 v13, v9 offset:40
    s_sub_u32 s62, s62, 1
    s_cselect_b32 s61, 0, 8
    s_waitcnt lgkmcnt(0)
    v_readfirstlane_b32 s63, v13
    s_nop 0
    s_cmp_lt_u32 s63, s61
    s_cbranch_scc1 LW_61
L_v_i0:
    s_cbranch_vccnz L_v_i0q
    s_waitcnt vmcnt(1)
L_v_i0q:
    s_waitcnt vmcnt(4)
    s_add_u32 s58, s56, s57
    s_and_b32 s58, s58, 15
    s_lshl_b32 s58, s58, 15
    s_add_u32 s58, s58, s54
    s_and_b32 s59, s56, 1
    s_lshl_b32 s59, s59, 6
    v_xor_b32 v3, s59, v4
    s_mov_b32 m0, s98
    s_add_u32 s98, s98, 1024
    s_add_u32 s56, s56, 1
    buffer_load_dwordx4 v3, s[12:15], s58 offen nt lds
    s_cmp_lt_u32 s56, 8
    s_cbranch_scc1 L_v_i0
L_v_mid:
    s_mov_b32 s62, 8000000
    s_branch LWc_64
LW_63:
    s_sleep 2
LWc_64:
    ds_read_b32 v13, v126 offset:64
    s_sub_u32 s62, s62, 1
    s_cselect_b32 s61, 0, 2
    s_waitcnt lgkmcnt(0)
    v_readfirstlane_b32 s63, v13
    s_nop 0
    s_cmp_lt_u32 s63, s61
    s_cbranch_scc1 LW_63
    s_add_u32 s98, s97, 65536
L_v_i1:
    s_cbranch_vccnz L_v_i1q
    s_waitcnt vmcnt(1)
L_v_i1q:
    s_waitcnt vmcnt(4)
    s_add_u32 s58, s56, s57
    s_and_b32 s58, s58, 15
    s_lshl_b32 s58, s58, 15
    s_add_u32 s58, s58, s54
    s_and_b32 s59, s56, 1
    s_lshl_b32 s59, s59, 6
    v_xor_b32 v3, s59, v4
    s_mov_b32 m0, s98
    s_add_u32 s98, s98, 1024
    s_add_u32 s56, s56, 1
    buffer_load_dwordx4 v3, s[12:15], s58 offen nt lds
    s_cmp_lt_u32 s56, 12
    s_cbranch_scc1 L_v_i1
    s_cmp_eq_u32 s55, 7
    s_cbranch_scc1 L_v_i2
    s_waitcnt vmcnt(4)
    s_cmp_lt_u32 s3, 3
    s_cbranch_scc1 L_v_tr2
    ds_write_b128 v96, v[16:19]
    ds_read_b64_tr_b16 v[16:17], v97
    ds_read_b64_tr_b16 v[18:19], v97 offset:512
    ds_write_b128 v96, v[20:23]
    ds_read_b64_tr_b16 v[20:21], v97
    ds_read_b64_tr_b16 v[22:23], v97 offset:512
    ds_write_b128 v96, v[24:27]
    ds_read_b64_tr_b16 v[24:25], v97
    ds_read_b64_tr_b16 v[26:27], v97 offset:512
    ds_write_b128 v96, v[28:31]
    ds_read_b64_tr_b16 v[28:29], v97
    ds_read_b64_tr_b16 v[30:31], v97 offset:512
    ds_write_b128 v96, v[32:35]
    ds_read_b64_tr_b16 v[32:33], v97
    ds_read_b64_tr_b16 v[34:35], v97 offset:512
    ds_write_b128 v96, v[36:39]
    ds_read_b64_tr_b16 v[36:37], v97
    ds_read_b64_tr_b16 v[38:39], v97 offset:512
    ds_write_b128 v96, v[40:43]
    ds_read_b64_tr_b16 v[40:41], v97
    ds_read_b64_tr_b16 v[42:43], v97 offset:512
    ds_write_b128 v96, v[44:47]
    ds_read_b64_tr_b16 v[44:45], v97
    ds_read_b64_tr_b16 v[46:47], v97 offset:512
L_v_tr2:
    ds_write_b128 v96, v[48:51]
    ds_read_b64_tr_b16 v[48:49], v97
    ds_read_b64_tr_b16 v[50:51], v97 offset:512
    ds_write_b128 v96, v[52:55]
    ds_read_b64_tr_b16 v[52:53], v97
    ds_read_b64_tr_b16 v[54:55], v97 offset:512
    ds_write_b128 v96, v[56:59]
    ds_read_b64_tr_b16 v[56:57], v97
    ds_read_b64_tr_b16 v[58:59], v97 offset:512
    ds_write_b128 v96, v[60:63]
    ds_read_b64_tr_b16 v[60:61], v97
    ds_read_b64_tr_b16 v[62:63], v97 offset:512
    ds_write_b128 v96, v[64:67]
    ds_read_b64_tr_b16 v[64:65], v97
    ds_read_b64_tr_b16 v[66:67], v97 offset:512
    ds_write_b128 v96, v[68:71]
    ds_read_b64_tr_b16 v[68:69], v97
    ds_read_b64_tr_b16 v[70:71], v97 offset:512
    ds_write_b128 v96, v[72:75]
    ds_read_b64_tr_b16 v[72:73], v97
    ds_read_b64_tr_b16 v[74:75], v97 offset:512
    ds_write_b128 v96, v[76:79]
    ds_read_b64_tr_b16 v[76:77], v97
    ds_read_b64_tr_b16 v[78:79], v97 offset:512
L_v_i2:
    s_cbranch_vccnz L_v_i2q
    s_waitcnt vmcnt(1)
L_v_i2q:
    s_waitcnt vmcnt(4)
    s_add_u32 s58, s56, s57
    s_and_b32 s58, s58, 15
    s_lshl_b32 s58, s58, 15
    s_add_u32 s58, s58, s54
    s_and_b32 s59, s56, 1
    s_lshl_b32 s59, s59, 6
    v_xor_b32 v3, s59, v4
    s_mov_b32 m0, s98
    s_add_u32 s98, s98, 1024
    s_add_u32 s56, s56, 1
    buffer_load_dwordx4 v3, s[12:15], s58 offen nt lds
    s_cmp_lt_u32 s56, 16
    s_cbranch_scc1 L_v_i2
    v_lshlrev_b32 v12, 3, v1
    v_add_u32 v12, 155904, v12
    v_lshrrev_b32 v11, 5, v1
    v_lshlrev_b32 v11, 13, v11
    v_and_b32 v3, 30, v1
    v_lshl_add_u32 v11, v3, 3, v11
    s_mul_i32 s58, s48, 7
    s_add_u32 s58, s58, s55
    s_lshl_b32 s58, s58, 14
    s_lshl_b32 s59, s46, 10
    s_add_u32 s58, s58, s59
    s_lshl_b32 s59, s47, 8
    s_add_u32 s58, s58, s59
    s_add_u32 s58, s58, 1048576
    s_mov_b32 s56, 0x55555555
    s_mov_b32 s57, 0x55555555
    s_waitcnt vmcnt(8)
    ds_read_b64_tr_b16 v[80:81], v5 offset:0
    ds_read_b64_tr_b16 v[82:83], v5 offset:512
    ds_read_b64_tr_b16 v[84:85], v2 offset:0
    ds_read_b64_tr_b16 v[86:87], v2 offset:512
    ds_read_b64_tr_b16 v[88:89], v7 offset:0
    ds_read_b64_tr_b16 v[90:91], v7 offset:512
    ds_read_b64_tr_b16 v[92:93], v8 offset:0
    ds_read_b64_tr_b16 v[94:95], v8 offset:512
    s_mov_b32 s62, 8000000
    s_branch LWc_66
LW_65:
    s_sleep 1
LWc_66:
    ds_read_b32 v13, v9 offset:20
    s_sub_u32 s62, s62, 1
    s_cselect_b32 s61, 0, 2
    s_waitcnt lgkmcnt(0)
    v_readfirstlane_b32 s63, v13
    s_nop 0
    s_cmp_lt_u32 s63, s61
    s_cbranch_scc1 LW_65
    ds_read_b128 v[96:99], v112
    ds_read_b128 v[100:103], v113
    ds_read_b128 v[104:107], v114
    ds_read_b128 v[108:111], v115
    s_waitcnt lgkmcnt(0)
    v_mfma_f32_16x16x32_bf16 v[112:115], v[96:99], v[80:83], 0
    v_mfma_f32_16x16x32_bf16 v[116:119], v[96:99], v[84:87], 0
    v_mfma_f32_16x16x32_bf16 v[120:123], v[96:99], v[88:91], 0
    v_mfma_f32_16x16x32_bf16 v[124:127], v[96:99], v[92:95], 0
    ds_read_b64_tr_b16 v[80:81], v5 offset:4096
    ds_read_b64_tr_b16 v[82:83], v5 offset:4608
    ds_read_b64_tr_b16 v[84:85], v2 offset:4096
    ds_read_b64_tr_b16 v[86:87], v2 offset:4608
    ds_read_b64_tr_b16 v[88:89], v7 offset:4096
    ds_read_b64_tr_b16 v[90:91], v7 offset:4608
    ds_read_b64_tr_b16 v[92:93], v8 offset:4096
    ds_read_b64_tr_b16 v[94:95], v8 offset:4608
    s_waitcnt lgkmcnt(6)
    v_mfma_f32_16x16x32_bf16 v[112:115], v[100:103], v[80:83], v[112:115]
    s_waitcnt lgkmcnt(4)
    v_mfma_f32_16x16x32_bf16 v[116:119], v[100:103], v[84:87], v[116:119]
    s_waitcnt lgkmcnt(2)
    v_mfma_f32_16x16x32_bf16 v[120:123], v[100:103], v[88:91], v[120:123]
    s_waitcnt lgkmcnt(0)
    v_mfma_f32_16x16x32_bf16 v[124:127], v[100:103], v[92:95], v[124:127]
    v_add_u32 v5, 0x10000, v5
    v_add_u32 v2, 0x10000, v2
    v_add_u32 v7, 0x10000, v7
    v_add_u32 v8, 0x10000, v8
    s_waitcnt vmcnt(4)
    ds_read_b64_tr_b16 v[80:81], v5 offset:0
    ds_read_b64_tr_b16 v[82:83], v5 offset:512
    ds_read_b64_tr_b16 v[84:85], v2 offset:0
    ds_read_b64_tr_b16 v[86:87], v2 offset:512
    ds_read_b64_tr_b16 v[88:89], v7 offset:0
    ds_read_b64_tr_b16 v[90:91], v7 offset:512
    ds_read_b64_tr_b16 v[92:93], v8 offset:0
    ds_read_b64_tr_b16 v[94:95], v8 offset:512
    s_waitcnt lgkmcnt(6)
    v_mfma_f32_16x16x32_bf16 v[112:115], v[104:107], v[80:83], v[112:115]
    s_waitcnt lgkmcnt(4)
    v_mfma_f32_16x16x32_bf16 v[116:119], v[104:107], v[84:87], v[116:119]
    s_waitcnt lgkmcnt(2)
    v_mfma_f32_16x16x32_bf16 v[120:123], v[104:107], v[88:91], v[120:123]
    s_waitcnt lgkmcnt(0)
    v_mfma_f32_16x16x32_bf16 v[124:127], v[104:107], v[92:95], v[124:127]
    s_waitcnt vmcnt(0)
    ds_read_b64_tr_b16 v[80:81], v5 offset:4096
    ds_read_b64_tr_b16 v[82:83], v5 offset:4608
    ds_read_b64_tr_b16 v[84:85], v2 offset:4096
    ds_read_b64_tr_b16 v[86:87], v2 offset:4608
    ds_read_b64_tr_b16 v[88:89], v7 offset:4096
    ds_read_b64_tr_b16 v[90:91], v7 offset:4608
    ds_read_b64_tr_b16 v[92:93], v8 offset:4096
    ds_read_b64_tr_b16 v[94:95], v8 offset:4608
    s_waitcnt lgkmcnt(6)
    v_mfma_f32_16x16x32_bf16 v[112:115], v[108:111], v[80:83], v[112:115]
    s_waitcnt lgkmcnt(4)
    v_mfma_f32_16x16x32_bf16 v[116:119], v[108:111], v[84:87], v[116:119]
    s_waitcnt lgkmcnt(2)
    v_mfma_f32_16x16x32_bf16 v[120:123], v[108:111], v[88:91], v[120:123]
    s_waitcnt lgkmcnt(0)
    v_mfma_f32_16x16x32_bf16 v[124:127], v[108:111], v[92:95], v[124:127]
    s_mov_b64 exec, 0xffff
    s_cmp_eq_u32 s55, 7
    s_nop 0
    ds_write2_b32 v10, v112, v113 offset0:0 offset1:64
    s_nop 0
    ds_write2_b32 v10, v116, v117 offset0:16 offset1:80
    s_nop 0
    ds_write2_b32 v10, v120, v121 offset0:32 offset1:96
    s_nop 0
    ds_write2_b32 v10, v124, v125 offset0:48 offset1:112
    s_mov_b64 exec, -1
    s_waitcnt lgkmcnt(0)
    s_barrier
    s_cbranch_scc1 L_v_7
    s_setprio 3
    ds_read_b64 v[80:81], v12 offset:0
    ds_read_b64 v[82:83], v12 offset:512
    ds_read_b64 v[84:85], v12 offset:1024
    ds_read_b64 v[86:87], v12 offset:1536
    ds_read_b64 v[88:89], v12 offset:2048
    ds_read_b64 v[90:91], v12 offset:2560
    ds_read_b64 v[92:93], v12 offset:3072
    ds_read_b64 v[94:95], v12 offset:3584
    v_mov_b32 v120, 0
    v_mov_b32 v121, 0
    v_mov_b32 v122, 0
    v_mov_b32 v123, 0
    s_waitcnt lgkmcnt(0)
    v_pk_add_f32 v[80:81], v[80:81], v[88:89]
    v_pk_add_f32 v[82:83], v[82:83], v[90:91]
    v_pk_add_f32 v[84:85], v[84:85], v[92:93]
    v_pk_add_f32 v[86:87], v[86:87], v[94:95]
    v_pk_add_f32 v[80:81], v[80:81], v[84:85]
    v_pk_add_f32 v[82:83], v[82:83], v[86:87]
    v_pk_add_f32 v[80:81], v[80:81], v[82:83]
    v_cvt_pk_bf16_f32 v96, v80, v81
    v_cvt_pk_bf16_f32 v97, v80, v81
    s_nop 1
    v_permlane16_swap_b32 v96, v97
    v_mov_b32 v98, v96
    v_mov_b32 v99, v97
    s_nop 0
    v_permlane32_swap_b32 v96, v98
    v_permlane32_swap_b32 v97, v99
    s_nop 0
    .p2align 3
    v_dot2c_f32_bf16_dpp v120, v96, v16 row_newbcast:0 row_mask:0xf bank_mask:0xf
    v_dot2c_f32_bf16_dpp v121, v96, v17 row_newbcast:1 row_mask:0xf bank_mask:0xf
    v_dot2c_f32_bf16_dpp v122, v96, v18 row_newbcast:2 row_mask:0xf bank_mask:0xf
    v_dot2c_f32_bf16_dpp v123, v96, v19 row_newbcast:3 row_mask:0xf bank_mask:0xf
    v_dot2c_f32_bf16_dpp v120, v96, v20 row_newbcast:4 row_mask:0xf bank_mask:0xf
    v_dot2c_f32_bf16_dpp v121, v96, v21 row_newbcast:5 row_mask:0xf bank_mask:0xf
    v_dot2c_f32_bf16_dpp v122, v96, v22 row_newbcast:6 row_mask:0xf bank_mask:0xf
    v_dot2c_f32_bf16_dpp v123, v96, v23 row_newbcast:7 row_mask:0xf bank_mask:0xf
    v_dot2c_f32_bf16_dpp v120, v96, v24 row_newbcast:8 row_mask:0xf bank_mask:0xf
    v_dot2c_f32_bf16_dpp v121, v96, v25 row_newbcast:9 row_mask:0xf bank_mask:0xf
    v_dot2c_f32_bf16_dpp v122, v96, v26 row_newbcast:10 row_mask:0xf bank_mask:0xf
    v_dot2c_f32_bf16_dpp v123, v96, v27 row_newbcast:11 row_mask:0xf bank_mask:0xf
    v_dot2c_f32_bf16_dpp v120, v96, v28 row_newbcast:12 row_mask:0xf bank_mask:0xf
    v_dot2c_f32_bf16_dpp v121, v96, v29 row_newbcast:13 row_mask:0xf bank_mask:0xf
    v_dot2c_f32_bf16_dpp v122, v96, v30 row_newbcast:14 row_mask:0xf bank_mask:0xf
    v_dot2c_f32_bf16_dpp v123, v96, v31 row_newbcast:15 row_mask:0xf bank_mask:0xf
    v_dot2c_f32_bf16_dpp v120, v97, v32 row_newbcast:0 row_mask:0xf bank_mask:0xf
    v_dot2c_f32_bf16_dpp v121, v97, v33 row_newbcast:1 row_mask:0xf bank_mask:0xf
    v_dot2c_f32_bf16_dpp v122, v97, v34 row_newbcast:2 row_mask:0xf bank_mask:0xf
    v_dot2c_f32_bf16_dpp v123, v97, v35 row_newbcast:3 row_mask:0xf bank_mask:0xf
    v_dot2c_f32_bf16_dpp v120, v97, v36 row_newbcast:4 row_mask:0xf bank_mask:0xf
    v_dot2c_f32_bf16_dpp v121, v97, v37 row_newbcast:5 row_mask:0xf bank_mask:0xf
    v_dot2c_f32_bf16_dpp v122, v97, v38 row_newbcast:6 row_mask:0xf bank_mask:0xf
    v_dot2c_f32_bf16_dpp v123, v97, v39 row_newbcast:7 row_mask:0xf bank_mask:0xf
    v_dot2c_f32_bf16_dpp v120, v97, v40 row_newbcast:8 row_mask:0xf bank_mask:0xf
    v_dot2c_f32_bf16_dpp v121, v97, v41 row_newbcast:9 row_mask:0xf bank_mask:0xf
    v_dot2c_f32_bf16_dpp v122, v97, v42 row_newbcast:10 row_mask:0xf bank_mask:0xf
    v_dot2c_f32_bf16_dpp v123, v97, v43 row_newbcast:11 row_mask:0xf bank_mask:0xf
    v_dot2c_f32_bf16_dpp v120, v97, v44 row_newbcast:12 row_mask:0xf bank_mask:0xf
    v_dot2c_f32_bf16_dpp v121, v97, v45 row_newbcast:13 row_mask:0xf bank_mask:0xf
    v_dot2c_f32_bf16_dpp v122, v97, v46 row_newbcast:14 row_mask:0xf bank_mask:0xf
    v_dot2c_f32_bf16_dpp v123, v97, v47 row_newbcast:15 row_mask:0xf bank_mask:0xf
    v_dot2c_f32_bf16_dpp v120, v98, v48 row_newbcast:0 row_mask:0xf bank_mask:0xf
    v_dot2c_f32_bf16_dpp v121, v98, v49 row_newbcast:1 row_mask:0xf bank_mask:0xf
    v_dot2c_f32_bf16_dpp v122, v98, v50 row_newbcast:2 row_mask:0xf bank_mask:0xf
    v_dot2c_f32_bf16_dpp v123, v98, v51 row_newbcast:3 row_mask:0xf bank_mask:0xf
    v_dot2c_f32_bf16_dpp v120, v98, v52 row_newbcast:4 row_mask:0xf bank_mask:0xf
    v_dot2c_f32_bf16_dpp v121, v98, v53 row_newbcast:5 row_mask:0xf bank_mask:0xf
    v_dot2c_f32_bf16_dpp v122, v98, v54 row_newbcast:6 row_mask:0xf bank_mask:0xf
    v_dot2c_f32_bf16_dpp v123, v98, v55 row_newbcast:7 row_mask:0xf bank_mask:0xf
    v_dot2c_f32_bf16_dpp v120, v98, v56 row_newbcast:8 row_mask:0xf bank_mask:0xf
    v_dot2c_f32_bf16_dpp v121, v98, v57 row_newbcast:9 row_mask:0xf bank_mask:0xf
    v_dot2c_f32_bf16_dpp v122, v98, v58 row_newbcast:10 row_mask:0xf bank_mask:0xf
    v_dot2c_f32_bf16_dpp v123, v98, v59 row_newbcast:11 row_mask:0xf bank_mask:0xf
    v_dot2c_f32_bf16_dpp v120, v98, v60 row_newbcast:12 row_mask:0xf bank_mask:0xf
    v_dot2c_f32_bf16_dpp v121, v98, v61 row_newbcast:13 row_mask:0xf bank_mask:0xf
    v_dot2c_f32_bf16_dpp v122, v98, v62 row_newbcast:14 row_mask:0xf bank_mask:0xf
    v_dot2c_f32_bf16_dpp v123, v98, v63 row_newbcast:15 row_mask:0xf bank_mask:0xf
    v_dot2c_f32_bf16_dpp v120, v99, v64 row_newbcast:0 row_mask:0xf bank_mask:0xf
    v_dot2c_f32_bf16_dpp v121, v99, v65 row_newbcast:1 row_mask:0xf bank_mask:0xf
    v_dot2c_f32_bf16_dpp v122, v99, v66 row_newbcast:2 row_mask:0xf bank_mask:0xf
    v_dot2c_f32_bf16_dpp v123, v99, v67 row_newbcast:3 row_mask:0xf bank_mask:0xf
    v_dot2c_f32_bf16_dpp v120, v99, v68 row_newbcast:4 row_mask:0xf bank_mask:0xf
    v_dot2c_f32_bf16_dpp v121, v99, v69 row_newbcast:5 row_mask:0xf bank_mask:0xf
    v_dot2c_f32_bf16_dpp v122, v99, v70 row_newbcast:6 row_mask:0xf bank_mask:0xf
    v_dot2c_f32_bf16_dpp v123, v99, v71 row_newbcast:7 row_mask:0xf bank_mask:0xf
    v_dot2c_f32_bf16_dpp v120, v99, v72 row_newbcast:8 row_mask:0xf bank_mask:0xf
    v_dot2c_f32_bf16_dpp v121, v99, v73 row_newbcast:9 row_mask:0xf bank_mask:0xf
    v_dot2c_f32_bf16_dpp v122, v99, v74 row_newbcast:10 row_mask:0xf bank_mask:0xf
    v_dot2c_f32_bf16_dpp v123, v99, v75 row_newbcast:11 row_mask:0xf bank_mask:0xf
    v_dot2c_f32_bf16_dpp v120, v99, v76 row_newbcast:12 row_mask:0xf bank_mask:0xf
    v_dot2c_f32_bf16_dpp v121, v99, v77 row_newbcast:13 row_mask:0xf bank_mask:0xf
    v_dot2c_f32_bf16_dpp v122, v99, v78 row_newbcast:14 row_mask:0xf bank_mask:0xf
    v_dot2c_f32_bf16_dpp v123, v99, v79 row_newbcast:15 row_mask:0xf bank_mask:0xf
    s_nop 1
    v_add_f32 v120, v120, v121
    s_nop 0
    v_add_f32 v122, v122, v123
    v_add_f32 v108, v120, v122
    v_xor_b32 v110, s50, v108
    s_nop 0
    v_mov_b32_dpp v109, v108 quad_perm:[1,1,3,3] row_mask:0xf bank_mask:0xf
    s_mov_b64 exec, s[56:57]
    v_xor_b32 v111, s51, v109
    buffer_store_dwordx4 v[108:111], v11, s[4:7], s58 offen sc1
    s_mov_b64 exec, 1
    ds_add_u32 v9, v15 offset:48
    s_mov_b64 exec, -1
L_v_7:
    s_cmp_lg_u32 s3, 1
    s_cbranch_scc1 L_fin
    s_setprio 2
    v_lshrrev_b32 v12, 3, v1
    v_lshlrev_b32 v12, 11, v12
    v_and_b32 v13, 7, v1
    v_lshl_add_u32 v12, v13, 5, v12
    s_lshl_b32 s58, s55, 8
    s_add_u32 s58, s58, 2205696
    s_add_u32 s59, s58, 14336
    v_mov_b32 v88, 0
    v_mov_b32 v89, 0
    s_mov_b32 exec_lo, -1
    s_mov_b32 exec_hi, 0x00ffffff
    s_mov_b32 s62, 1000000
G_67:
Gc_68:
    buffer_load_dwordx4 v[44:47], v12, s[4:7], s58 offen offset:0 sc1
    buffer_load_dwordx4 v[48:51], v12, s[4:7], s58 offen offset:16 sc1
    buffer_load_dwordx4 v[52:55], v12, s[4:7], s59 offen offset:0 sc1
    buffer_load_dwordx4 v[56:59], v12, s[4:7], s59 offen offset:16 sc1
    s_sub_u32 s62, s62, 1
    s_cselect_b64 s[60:61], 0, -1
    s_waitcnt vmcnt(3)
    v_bitop3_b32 v14, v44, v46, s50 bitop3:0x96
    v_bitop3_b32 v3, v45, v47, s51 bitop3:0x96
    v_or_b32 v13, v14, v3
    s_waitcnt vmcnt(2)
    v_bitop3_b32 v14, v48, v50, s50 bitop3:0x96
    v_bitop3_b32 v3, v49, v51, s51 bitop3:0x96
    v_or3_b32 v13, v13, v14, v3
    s_waitcnt vmcnt(1)
    v_bitop3_b32 v14, v52, v54, s50 bitop3:0x96
    v_bitop3_b32 v3, v53, v55, s51 bitop3:0x96
    v_or3_b32 v13, v13, v14, v3
    s_waitcnt vmcnt(0)
    v_bitop3_b32 v14, v56, v58, s50 bitop3:0x96
    v_bitop3_b32 v3, v57, v59, s51 bitop3:0x96
    v_or3_b32 v13, v13, v14, v3
    v_cmp_ne_u32 vcc, 0, v13
    s_and_b64 vcc, vcc, s[60:61]
    s_cbranch_scc1 G_67
    v_lshlrev_b32 v60, 16, v44
    v_and_b32 v61, 0xffff0000, v44
    v_lshlrev_b32 v62, 16, v45
    v_and_b32 v63, 0xffff0000, v45
    v_lshlrev_b32 v64, 16, v48
    v_and_b32 v65, 0xffff0000, v48
    v_lshlrev_b32 v66, 16, v49
    v_and_b32 v67, 0xffff0000, v49
    v_lshlrev_b32 v68, 16, v52
    v_and_b32 v69, 0xffff0000, v52
    v_lshlrev_b32 v70, 16, v53
    v_and_b32 v71, 0xffff0000, v53
    v_lshlrev_b32 v72, 16, v56
    v_and_b32 v73, 0xffff0000, v56
    v_lshlrev_b32 v74, 16, v57
    v_and_b32 v75, 0xffff0000, v57
    v_pk_add_f32 v[68:69], v[68:69], 1.0 op_sel_hi:[1,0]
    v_pk_add_f32 v[70:71], v[70:71], 1.0 op_sel_hi:[1,0]
    v_pk_add_f32 v[72:73], v[72:73], 1.0 op_sel_hi:[1,0]
    v_pk_add_f32 v[74:75], v[74:75], 1.0 op_sel_hi:[1,0]
    v_cvt_pk_bf16_f32 v13, v68, v69
    v_lshlrev_b32 v68, 16, v13
    v_and_b32 v69, 0xffff0000, v13
    v_cvt_pk_bf16_f32 v13, v70, v71
    v_lshlrev_b32 v70, 16, v13
    v_and_b32 v71, 0xffff0000, v13
    v_cvt_pk_bf16_f32 v13, v72, v73
    v_lshlrev_b32 v72, 16, v13
    v_and_b32 v73, 0xffff0000, v13
    v_cvt_pk_bf16_f32 v13, v74, v75
    v_lshlrev_b32 v74, 16, v13
    v_and_b32 v75, 0xffff0000, v13
    v_lshlrev_b32 v12, 5, v1
    s_mul_i32 s58, s55, 1792
    s_add_u32 s58, s58, 20480
    s_mul_i32 s53, s55, 1056
    s_add_u32 s53, s53, 138240
    v_lshlrev_b32 v11, 4, v1
    v_add_u32 v11, s53, v11
    s_mov_b32 s62, 8000000
    s_branch LWc_70
LW_69:
    s_sleep 2
LWc_70:
    ds_read_b32 v13, v9 offset:8
    s_sub_u32 s62, s62, 1
    s_cselect_b32 s61, 0, 8
    s_waitcnt lgkmcnt(0)
    v_readfirstlane_b32 s63, v13
    s_nop 0
    s_cmp_lt_u32 s63, s61
    s_cbranch_scc1 LW_69
    s_mov_b32 s62, 1000000
G_71:
Gc_72:
    buffer_load_dwordx4 v[44:47], v12, s[4:7], s58 offen offset:0 sc1
    buffer_load_dwordx4 v[48:51], v12, s[4:7], s58 offen offset:16 sc1
    s_sub_u32 s62, s62, 1
    s_cselect_b64 s[60:61], 0, -1
    s_waitcnt vmcnt(1)
    v_bitop3_b32 v14, v44, v46, s50 bitop3:0x96
    v_bitop3_b32 v3, v45, v47, s51 bitop3:0x96
    v_or_b32 v13, v14, v3
    s_waitcnt vmcnt(0)
    v_bitop3_b32 v14, v48, v50, s50 bitop3:0x96
    v_bitop3_b32 v3, v49, v51, s51 bitop3:0x96
    v_or3_b32 v13, v13, v14, v3
    v_cmp_ne_u32 vcc, 0, v13
    s_and_b64 vcc, vcc, s[60:61]
    s_cbranch_scc1 G_71
    v_lshlrev_b32 v80, 16, v44
    v_and_b32 v81, 0xffff0000, v44
    v_lshlrev_b32 v82, 16, v45
    v_and_b32 v83, 0xffff0000, v45
    v_lshlrev_b32 v84, 16, v48
    v_and_b32 v85, 0xffff0000, v48
    v_lshlrev_b32 v86, 16, v49
    v_and_b32 v87, 0xffff0000, v49
    v_readfirstlane_b32 s56, v80
    s_nop 0
    s_mov_b32 s57, s56
    v_pk_add_f32 v[92:93], v[80:81], s[56:57] neg_lo:[0,1] neg_hi:[0,1]
    v_pk_add_f32 v[90:91], v[82:83], s[56:57] neg_lo:[0,1] neg_hi:[0,1]
    v_pk_mul_f32 v[94:95], v[92:93], v[92:93]
    v_pk_add_f32 v[92:93], v[92:93], v[90:91]
    v_pk_fma_f32 v[94:95], v[90:91], v[90:91], v[94:95]
    v_pk_add_f32 v[90:91], v[84:85], s[56:57] neg_lo:[0,1] neg_hi:[0,1]
    v_pk_add_f32 v[92:93], v[92:93], v[90:91]
    v_pk_fma_f32 v[94:95], v[90:91], v[90:91], v[94:95]
    v_pk_add_f32 v[90:91], v[86:87], s[56:57] neg_lo:[0,1] neg_hi:[0,1]
    v_pk_add_f32 v[92:93], v[92:93], v[90:91]
    v_pk_fma_f32 v[94:95], v[90:91], v[90:91], v[94:95]
    v_add_f32 v88, v92, v93
    v_add_f32 v89, v94, v95
    s_mov_b64 exec, -1
    s_nop 0
    v_add_f32_dpp v88, v88, v88 quad_perm:[1,0,3,2] row_mask:0xf bank_mask:0xf
    v_add_f32_dpp v89, v89, v89 quad_perm:[1,0,3,2] row_mask:0xf bank_mask:0xf
    s_nop 0
    v_add_f32_dpp v88, v88, v88 quad_perm:[2,3,0,1] row_mask:0xf bank_mask:0xf
    v_add_f32_dpp v89, v89, v89 quad_perm:[2,3,0,1] row_mask:0xf bank_mask:0xf
    s_nop 0
    v_add_f32_dpp v88, v88, v88 row_half_mirror row_mask:0xf bank_mask:0xf
    v_add_f32_dpp v89, v89, v89 row_half_mirror row_mask:0xf bank_mask:0xf
    s_nop 0
    v_add_f32_dpp v88, v88, v88 row_mirror row_mask:0xf bank_mask:0xf
    v_add_f32_dpp v89, v89, v89 row_mirror row_mask:0xf bank_mask:0xf
    v_mov_b32 v90, v88
    v_mov_b32 v91, v89
    s_nop 0
    v_permlane16_swap_b32 v90, v88
    v_permlane16_swap_b32 v91, v89
    v_add_f32 v88, v88, v90
    v_add_f32 v89, v89, v91
    v_mov_b32 v90, v88
    v_mov_b32 v91, v89
    s_nop 0
    v_permlane32_swap_b32 v90, v88
    v_permlane32_swap_b32 v91, v89
    v_add_f32 v88, v88, v90
    v_add_f32 v89, v89, v91
    v_mul_f32 v88, 0x3b124925, v88
    v_mul_f32 v89, 0x3b124925, v89
    v_fma_f32 v89, -v88, v88, v89
    v_max_f32 v89, 0, v89
    v_add_f32 v92, s56, v88
    v_cvt_pk_bf16_f32 v90, v92, v89
    v_lshlrev_b32 v92, 16, v90
    v_and_b32 v89, 0xffff0000, v90
    v_add_f32 v89, 0x3727c5ac, v89
    v_cvt_pk_bf16_f32 v89, v89, v89
    v_and_b32 v89, 0xffff0000, v89
    v_sqrt_f32 v89, v89
    v_pk_add_f32 v[80:81], v[80:81], v[92:93] op_sel_hi:[1,0] neg_lo:[0,1] neg_hi:[0,1]
    v_pk_add_f32 v[82:83], v[82:83], v[92:93] op_sel_hi:[1,0] neg_lo:[0,1] neg_hi:[0,1]
    v_cvt_pk_bf16_f32 v89, v89, v89
    v_and_b32 v89, 0xffff0000, v89
    v_rcp_f32 v94, v89
    v_pk_add_f32 v[84:85], v[84:85], v[92:93] op_sel_hi:[1,0] neg_lo:[0,1] neg_hi:[0,1]
    v_pk_add_f32 v[86:87], v[86:87], v[92:93] op_sel_hi:[1,0] neg_lo:[0,1] neg_hi:[0,1]
    v_cvt_pk_bf16_f32 v90, v80, v81
    v_lshlrev_b32 v80, 16, v90
    v_and_b32 v81, 0xffff0000, v90
    v_pk_mul_f32 v[80:81], v[80:81], v[94:95] op_sel_hi:[1,0]
    v_cvt_pk_bf16_f32 v90, v82, v83
    v_lshlrev_b32 v82, 16, v90
    v_and_b32 v83, 0xffff0000, v90
    v_pk_mul_f32 v[82:83], v[82:83], v[94:95] op_sel_hi:[1,0]
    v_cvt_pk_bf16_f32 v90, v84, v85
    v_lshlrev_b32 v84, 16, v90
    v_and_b32 v85, 0xffff0000, v90
    v_pk_mul_f32 v[84:85], v[84:85], v[94:95] op_sel_hi:[1,0]
    v_cvt_pk_bf16_f32 v90, v86, v87
    v_lshlrev_b32 v86, 16, v90
    v_and_b32 v87, 0xffff0000, v90
    v_pk_mul_f32 v[86:87], v[86:87], v[94:95] op_sel_hi:[1,0]
    v_cvt_pk_bf16_f32 v90, v80, v81
    v_lshlrev_b32 v80, 16, v90
    v_and_b32 v81, 0xffff0000, v90
    v_cvt_pk_bf16_f32 v90, v82, v83
    v_lshlrev_b32 v82, 16, v90
    v_and_b32 v83, 0xffff0000, v90
    v_cvt_pk_bf16_f32 v90, v84, v85
    v_lshlrev_b32 v84, 16, v90
    v_and_b32 v85, 0xffff0000, v90
    v_cvt_pk_bf16_f32 v90, v86, v87
    v_lshlrev_b32 v86, 16, v90
    v_and_b32 v87, 0xffff0000, v90
    s_mov_b32 exec_lo, -1
    s_mov_b32 exec_hi, 0x00ffffff
    v_pk_mul_f32 v[80:81], v[80:81], v[68:69]
    v_cvt_pk_bf16_f32 v13, v80, v81
    v_lshlrev_b32 v80, 16, v13
    v_and_b32 v81, 0xffff0000, v13
    v_pk_add_f32 v[80:81], v[80:81], v[60:61]
    v_cvt_pk_bf16_f32 v44, v80, v81
    v_pk_mul_f32 v[82:83], v[82:83], v[70:71]
    v_cvt_pk_bf16_f32 v13, v82, v83
    v_lshlrev_b32 v82, 16, v13
    v_and_b32 v83, 0xffff0000, v13
    v_pk_add_f32 v[82:83], v[82:83], v[62:63]
    v_cvt_pk_bf16_f32 v45, v82, v83
    v_pk_mul_f32 v[84:85], v[84:85], v[72:73]
    v_cvt_pk_bf16_f32 v13, v84, v85
    v_lshlrev_b32 v84, 16, v13
    v_and_b32 v85, 0xffff0000, v13
    v_pk_add_f32 v[84:85], v[84:85], v[64:65]
    v_cvt_pk_bf16_f32 v46, v84, v85
    v_pk_mul_f32 v[86:87], v[86:87], v[74:75]
    v_cvt_pk_bf16_f32 v13, v86, v87
    v_lshlrev_b32 v86, 16, v13
    v_and_b32 v87, 0xffff0000, v13
    v_pk_add_f32 v[86:87], v[86:87], v[66:67]
    v_cvt_pk_bf16_f32 v47, v86, v87
    ds_write_b128 v11, v[44:47]
    s_waitcnt lgkmcnt(0)
    s_barrier
L_fin:
L_end:
    s_endpgm
L_codeend:
.section .rodata,"a"
.p2align 6
.amdhsa_kernel adaLN_cond__sliding_block_cached__glu_gated_swiglu__decode_kernel
  .amdhsa_next_free_vgpr 128
  .amdhsa_next_free_sgpr 102
  .amdhsa_accum_offset 128
  .amdhsa_group_segment_fixed_size 0
  .amdhsa_kernarg_size 112
  .amdhsa_user_sgpr_count 2
  .amdhsa_user_sgpr_kernarg_segment_ptr 1
  .amdhsa_system_sgpr_workgroup_id_x 1
  .amdhsa_float_denorm_mode_32 3
.end_amdhsa_kernel
```
